```python
import torch

def _softmax(x, axis=-1):
    return torch.softmax(x, dim=axis)
def _gelu(x):
    return torch.nn.functional.gelu(x, approximate="tanh")
def _silu(x):
    return torch.nn.functional.silu(x)
def _sigmoid(x):
    return torch.sigmoid(x)
def _layernorm(x, axis=-1, eps=1e-5):
    m = x.mean(dim=axis, keepdim=True)
    v = x.var(dim=axis, keepdim=True, unbiased=False)
    return (x - m) / torch.sqrt(v + eps)
def _scatter_add(tgt, idx, src, axis=0):
    return tgt.clone().index_add_(axis, idx, src)
def _segment_sum(src, seg, n):
    out = torch.zeros((n,) + src.shape[1:], dtype=src.dtype)
    return out.index_add_(0, seg, src)
def _pad(x, pw):
    flat = tuple(v for pair in reversed(pw) for v in pair)
    return torch.nn.functional.pad(x, flat)

kernel_name = 'parallel_sum__ssm_conv_s4d__glu_gated_bilinear__prompt'

def setup_inputs():

    _w = (lambda a: (lambda t: t.to(torch.bfloat16) if t.is_floating_point() else t)(torch.as_tensor(a)))
    def _A_setup():
        Bsz, L, D, N = 1, 2048, 512, 128
        return {
            "u": _w((lambda *s: torch.randn(*s, dtype=torch.bfloat16) * 0.05)(Bsz, L, D)),
            "log_A_real": _w((lambda *s: torch.randn(*s, dtype=torch.bfloat16) * 6.4)(D, N) * 0.5),
            "A_imag": _w((lambda *s: torch.randn(*s, dtype=torch.bfloat16) * 0.05)(D, N) * 3.14),
            "C_real": _w((lambda *s: torch.randn(*s, dtype=torch.bfloat16) * 0.05)(D, N) / N ** 0.5),
            "C_imag": _w((lambda *s: torch.randn(*s, dtype=torch.bfloat16) * 0.05)(D, N) / N ** 0.5),
            "log_dt": _w((lambda *s: torch.randn(*s, dtype=torch.bfloat16) * 0.05)(D) * 0.5 - 4.0),
            "D_skip": _w((lambda *s: torch.randn(*s, dtype=torch.bfloat16) * 0.05)(D)),
        }
    _A_in = _A_setup()

    def _B_setup():
        B, S, D, F = 1, 2048, 512, 1792
        return {
            "x": _w((lambda *s: torch.randn(*s, dtype=torch.bfloat16) * 0.05)(B, S, D)),
            "w_gate": _w((lambda *s: torch.randn(*s, dtype=torch.bfloat16) * 0.4)(D, F) * (D ** -0.5)),
            "w_up": _w((lambda *s: torch.randn(*s, dtype=torch.bfloat16) * 0.4)(D, F) * (D ** -0.5)),
            "w_down": _w((lambda *s: torch.randn(*s, dtype=torch.bfloat16) * 0.4)(F, D) * (F ** -0.5)),
        }
    _B_in = _B_setup()

    return {
        "A_u": _A_in["u"],
        "A_log_A_real": _A_in["log_A_real"],
        "A_A_imag": _A_in["A_imag"],
        "A_C_real": _A_in["C_real"],
        "A_C_imag": _A_in["C_imag"],
        "A_log_dt": _A_in["log_dt"],
        "A_D_skip": _A_in["D_skip"],
        "B_x": _B_in["x"],
        "B_w_gate": _B_in["w_gate"],
        "B_w_up": _B_in["w_up"],
        "B_w_down": _B_in["w_down"],
    }

def reference(A_u, A_log_A_real, A_A_imag, A_C_real, A_C_imag, A_log_dt, A_D_skip, B_x, B_w_gate, B_w_up, B_w_down):
    def _A_ref(u, log_A_real, A_imag, C_real, C_imag, log_dt, D_skip):
        L = u.shape[1]
        dt = torch.exp(log_dt)
        A = -torch.exp(log_A_real) + 1j * A_imag
        C = (C_real + 1j * C_imag) * dt[:, None]
        pos = (lambda x, dt: x.to(dt))(torch.arange(L), log_dt.dtype)
        P = torch.exp((A * dt[:, None])[:, :, None] * pos[None, None, :])
        K = 2.0 * torch.einsum("dn,dnl->dl", C, P).real
        L2 = 2 * L
        u_t = (lambda x, *d: x.permute(*d))(u, 0, 2, 1)
        Kf = (lambda x, *a, **k: torch.fft.rfft(x.float(), *a, **k))(K, L2)
        Uf = (lambda x, *a, **k: torch.fft.rfft(x.float(), *a, **k))(u_t, L2)
        y = (lambda x, *a, **k: torch.fft.irfft(x, *a, **k).to(torch.bfloat16))(Uf * Kf[None, :, :], L2)[:, :, :L]
        y = (lambda x, *d: x.permute(*d))(y, 0, 2, 1)
        return y + u * D_skip[None, None, :]

    def _B_ref(x, w_gate, w_up, w_down):
        g = torch.einsum("bsd,df->bsf", x, w_gate)
        u = torch.einsum("bsd,df->bsf", x, w_up)
        h = g * u
        return torch.einsum("bsf,fd->bsd", h, w_down)

    x = A_u
    xn = _layernorm(x, axis=-1)
    return x + _A_ref(xn, A_log_A_real, A_A_imag, A_C_real, A_C_imag, A_log_dt, A_D_skip) + _B_ref(xn, B_w_gate, B_w_up, B_w_down)
```

```asm
; @launch grid=(256,1,1) block=(512,1,1) lds=163840
.amdgcn_target "amdgcn-amd-amdhsa--gfx950"
.text
.globl parallel_sum__ssm_conv_s4d__glu_gated_bilinear__prompt_kernel
.p2align 8
.type parallel_sum__ssm_conv_s4d__glu_gated_bilinear__prompt_kernel,@function
parallel_sum__ssm_conv_s4d__glu_gated_bilinear__prompt_kernel:
    s_memrealtime s[80:81]
    s_load_dwordx16 s[16:31], s[0:1], 0
    s_load_dwordx8 s[32:39], s[0:1], 64
    s_load_dwordx4 s[40:43], s[0:1], 96
    s_cmp_ge_u32 s2, 256
    s_cbranch_scc1 L_end
    v_lshrrev_b32 v1, 6, v0
    s_getpc_b64 s[76:77]
L_pc:
    v_readfirstlane_b32 s3, v1
    s_sub_u32 s76, s76, L_pc-parallel_sum__ssm_conv_s4d__glu_gated_bilinear__prompt_kernel
    s_subb_u32 s77, s77, 0
    s_mov_b32 s78, L_codeend-parallel_sum__ssm_conv_s4d__glu_gated_bilinear__prompt_kernel
    s_mov_b32 s79, 0x20000
    s_andn2_b32 s13, s2, 7
    v_add_lshl_u32 v1, v1, s13, 7
    buffer_load_dword v127, v1, s[76:79], 0 offen
    v_and_b32 v0, 63, v0
    s_and_b32 s4, s2, 7
    s_lshr_b32 s5, s2, 3
    s_lshl_b32 s10, s4, 5
    s_add_u32 s10, s10, s5
    s_and_b32 s12, s3, 3
    s_and_b32 s96, s3, 1
    s_bfe_u32 s97, s3, 0x10001
    s_lshl_b32 s13, s10, 1
    s_add_u32 s95, s13, s96
    s_lshl_b32 s13, s95, 8
    v_lshl_add_u32 v13, v0, 2, s13
    s_lshl_b32 s14, s97, 7
    s_add_u32 s13, s13, s14
    v_lshl_add_u32 v12, v0, 1, s13
    v_lshlrev_b32 v1, 4, v0
    s_lshl_b32 s92, s2, 13
    s_lshl_b32 s14, s12, 11
    s_add_u32 s92, s92, s14
    v_add_u32 v2, s92, v1
    s_lshl_b32 s94, s95, 1
    v_mov_b32 v21, s94
    s_lshl_b32 s13, s3, 2
    s_add_u32 s13, s13, 163792
    v_mov_b32 v16, s13
    v_mov_b32 v18, 0
    s_mov_b64 exec, 1
    ds_write_b32 v16, v18
    s_mov_b64 exec, -1
    v_and_b32 v26, 3, v0
    v_lshlrev_b32 v17, 2, v26
    v_add_u32 v17, 163792, v17
    s_and_b32 s13, s5, 3
    s_lshr_b32 s14, s5, 2
    s_and_b32 s15, s4, 3
    s_lshl_b32 s6, s15, 2
    s_add_u32 s6, s6, s13
    s_lshr_b32 s7, s4, 2
    s_mul_i32 s7, s7, 7
    s_add_u32 s7, s7, s14
    s_lshl_b32 s11, s15, 1
    s_add_u32 s93, s13, s14
    s_and_b32 s93, s93, 1
    s_lshl_b32 s8, s4, 2
    s_lshr_b32 s15, s5, 3
    s_add_u32 s8, s8, s15
    s_and_b32 s9, s5, 7
    s_cmp_lt_u32 s5, 28
    s_cselect_b32 s50, 0x200000, 0
    s_cselect_b32 s54, 1835008, 0
    s_cselect_b32 s74, 12582912, 0
    s_mov_b32 s47, 0x20000
    s_mov_b32 s51, 0x20000
    s_mov_b32 s55, 0x20000
    s_mov_b32 s59, 0x20000
    s_mov_b32 s63, 0x20000
    s_mov_b32 s67, 0x20000
    s_mov_b32 s71, 0x20000
    s_mov_b32 s75, 0x20000
    s_mov_b32 s46, 0x200000
    s_mov_b32 s58, 1835008
    s_mov_b32 s62, 0x200000
    s_mov_b32 s66, 256
    s_mov_b32 s70, 12582912
    v_lshrrev_b32 v22, 3, v0
    v_and_b32 v23, 7, v0
    v_lshrrev_b32 v24, 4, v0
    v_bfe_u32 v25, v0, 2, 2
    v_and_b32 v27, 15, v0
    s_lshl_b32 s98, s12, 12
    s_waitcnt lgkmcnt(0)
    s_cmp_ge_u32 s3, 4
    s_cbranch_scc1 L_X
    global_load_ushort v14, v12, s[18:19]
    global_load_ushort v15, v12, s[20:21]
    global_load_ushort v20, v21, s[26:27]
    global_load_ushort v32, v12, s[22:23]
    global_load_ushort v33, v12, s[24:25]
    global_load_dword v34, v13, s[22:23]
    global_load_dword v35, v13, s[24:25]
    s_barrier
    s_mov_b64 s[44:45], s[16:17]
    s_mov_b64 s[48:49], s[16:17]
    s_bitcmp1_b32 s3, 0
    s_cselect_b32 s52, s34, s32
    s_cselect_b32 s53, s35, s33
    s_mov_b64 s[68:69], s[42:43]
    s_mov_b64 s[72:73], s[42:43]
    s_mov_b64 s[56:57], s[36:37]
    s_mov_b64 s[60:61], s[38:39]
    s_mov_b64 s[64:65], s[40:41]
    s_lshl_b32 s13, s6, 1
    s_add_u32 s13, s13, s96
    s_lshl_b32 s14, s7, 1
    s_add_u32 s14, s14, s97
    s_mul_i32 s101, s13, 28
    s_add_u32 s101, s101, s14
    s_lshl_b32 s101, s101, 13
    s_add_u32 s101, s101, 4194304
    s_lshl_b32 s15, s96, 12
    s_add_u32 s101, s101, s15
    s_xor_b32 s93, s101, 4096
    s_lshl_b32 s13, s13, 5
    s_add_u32 s13, s13, s14
    s_lshl_b32 s13, s13, 5
    s_add_u32 s100, s13, 11862016
    s_cmp_eq_u32 s9, 7
    s_cselect_b32 s99, 3, s9
    s_mov_b32 s79, s99
    s_add_u32 s99, s99, 5
    s_cmp_ge_u32 s99, 7
    s_cselect_b32 s14, 7, 0
    s_sub_u32 s99, s99, s14
    s_mul_i32 s78, s12, 458752
    s_lshl_b32 s13, s9, 7
    s_add_u32 s78, s78, s13
    s_and_b32 s13, s8, 1
    s_lshl_b32 s13, s13, 15
    s_add_u32 s78, s78, s13
    s_lshl_b32 s13, s2, 5
    s_lshl_b32 s14, s12, 2
    s_add_u32 s13, s13, s14
    s_add_u32 s76, s13, 11927552
    s_lshl_b32 s13, s2, 7
    s_lshl_b32 s14, s12, 5
    s_add_u32 s13, s13, s14
    s_add_u32 s94, s13, 11796480
    s_lshl_b32 s13, s10, 13
    s_lshl_b32 s14, s12, 11
    s_add_u32 s13, s13, s14
    s_add_u32 s95, s13, 2097152
    v_lshlrev_b32 v28, 10, v24
    v_lshl_add_u32 v28, v25, 7, v28
    v_lshl_add_u32 v28, v26, 3, v28
    v_and_b32 v29, 1, v24
    v_xor_b32 v29, s96, v29
    v_lshlrev_b32 v29, 1, v29
    v_lshrrev_b32 v30, 1, v25
    v_or_b32 v29, v29, v30
    v_lshlrev_b32 v29, 5, v29
    s_lshl_b32 s13, s97, 12
    v_add_u32 v28, s13, v28
    v_xor_b32 v8, 0, v29
    v_add_u32 v8, v8, v28
    v_xor_b32 v9, 32, v29
    v_add_u32 v9, v9, v28
    v_xor_b32 v10, 64, v29
    v_add_u32 v10, v10, v28
    v_xor_b32 v11, 96, v29
    v_add_u32 v11, v11, v28
    v_lshrrev_b32 v29, 1, v27
    v_xor_b32 v29, v29, v24
    v_lshlrev_b32 v29, 4, v29
    v_lshl_add_u32 v2, v27, 7, v29
    s_lshl_b32 s13, s96, 13
    s_add_u32 s13, s13, 65536
    v_add_u32 v2, s13, v2
    v_xor_b32 v3, 64, v2
    s_mul_i32 s13, s12, 2176
    s_add_u32 s13, s13, 155296
    v_and_b32 v124, 1, v0
    v_mul_u32_u24 v124, 1088, v124
    v_add_u32 v124, s13, v124
    v_mul_u32_u24 v125, 1088, v25
    v_lshl_add_u32 v125, v24, 5, v125
    v_lshl_add_u32 v125, v26, 3, v125
    s_lshl_b32 s13, s12, 8
    s_add_u32 s13, s13, 154272
    v_add_u32 v125, s13, v125
    s_mul_i32 s13, s96, 16896
    s_lshl_b32 s14, s97, 8
    s_add_u32 s13, s13, s14
    s_add_u32 s13, s13, 120480
    v_lshl_add_u32 v12, v0, 2, s13
    s_mul_i32 s13, s96, 11088
    s_add_u32 s13, s13, s14
    s_add_u32 s13, s13, 98304
    v_lshl_add_u32 v13, v0, 2, s13
    s_lshl_b32 s13, s96, 2
    s_add_u32 s13, s13, 163824
    v_mov_b32 v4, s13
    v_mov_b32 v64, 1.0
    v_mov_b32 v65, 0
    s_waitcnt vmcnt(0)
    s_mov_b32 s13, 0x3fb8aa3b
    s_mov_b32 s14, 0x32a57060
    v_lshlrev_b32 v20, 16, v20
    v_lshlrev_b32 v14, 16, v14
    v_lshlrev_b32 v15, 16, v15
    v_mul_f32 v28, s13, v20
    v_mul_f32 v30, s13, v14
    v_fma_f32 v29, v20, s13, -v28
    v_fma_f32 v31, v14, s13, -v30
    v_fmac_f32 v29, s14, v20
    v_fmac_f32 v31, s14, v14
    v_exp_f32 v28, v28
    v_exp_f32 v30, v30
    v_mul_f32 v29, 0x3f317218, v29
    v_mul_f32 v31, 0x3f317218, v31
    v_fma_f32 v20, v28, v29, v28
    v_fma_f32 v14, v30, v31, v30
    v_cvt_pk_bf16_f32 v20, v20, v20
    v_cvt_pk_bf16_f32 v14, v14, v14
    v_and_b32 v20, 0xffff0000, v20
    v_and_b32 v14, 0xffff0000, v14
    v_mul_f32 v14, v14, v20
    v_mul_f32 v15, v15, v20
    v_mul_f32 v14, 0xbfb8aa3b, v14
    v_mul_f32 v15, 0.15915494, v15
    v_lshlrev_b32 v21, 16, v34
    v_and_b32 v34, 0xffff0000, v34
    v_lshlrev_b32 v36, 16, v35
    v_and_b32 v35, 0xffff0000, v35
    v_max3_f32 v21, |v21|, |v34|, |v36|
    v_max_f32 v21, |v35|, v21
    v_mul_f32 v28, 0x41000000, v14
    v_mul_f32 v30, 0x43000000, v14
    v_max_f32_dpp v21, v21, v21 quad_perm:[1,0,3,2] row_mask:0xf bank_mask:0xf
    v_mul_f32 v40, 1.0, v14
    v_mul_f32 v42, 0x43800000, v14
    v_max_f32_dpp v21, v21, v21 quad_perm:[2,3,0,1] row_mask:0xf bank_mask:0xf
    v_mul_f32 v29, 0x41000000, v15
    v_mul_f32 v31, 0x43000000, v15
    v_max_f32_dpp v21, v21, v21 row_half_mirror row_mask:0xf bank_mask:0xf
    v_mul_f32 v41, 1.0, v15
    v_mul_f32 v43, 0x43800000, v15
    v_max_f32_dpp v21, v21, v21 row_mirror row_mask:0xf bank_mask:0xf
    v_exp_f32 v28, v28
    v_exp_f32 v30, v30
    v_max_f32_dpp v21, v21, v21 row_bcast:15 row_mask:0xa bank_mask:0xf
    v_exp_f32 v40, v40
    v_exp_f32 v42, v42
    v_max_f32_dpp v21, v21, v21 row_bcast:31 row_mask:0xc bank_mask:0xf
    v_fract_f32 v29, v29
    v_fract_f32 v31, v31
    v_lshlrev_b32 v32, 16, v32
    v_fract_f32 v41, v41
    v_fract_f32 v43, v43
    v_lshlrev_b32 v33, 16, v33
    v_cos_f32 v38, v29
    v_cos_f32 v68, v31
    v_mul_f32 v21, v21, v20
    v_cos_f32 v34, v41
    v_cos_f32 v36, v43
    v_mul_f32 v32, v32, v20
    v_sin_f32 v39, v29
    v_sin_f32 v69, v31
    v_mul_f32 v33, v33, v20
    v_sin_f32 v35, v41
    v_sin_f32 v37, v43
    v_readlane_b32 s14, v21, 63
    v_mul_f32 v38, v38, v28
    v_mul_f32 v68, v68, v30
    v_mul_f32 v34, v34, v40
    v_mul_f32 v36, v36, v42
    v_mul_f32 v39, v39, v28
    v_mul_f32 v69, v69, v30
    v_mul_f32 v35, v35, v40
    v_mul_f32 v37, v37, v42
    s_lshr_b32 s14, s14, 23
    s_max_u32 s14, s14, 16
    s_min_u32 s14, s14, 250
    s_sub_u32 s15, 258, s14
    s_lshl_b32 s15, s15, 23
    s_sub_u32 s14, s14, 3
    s_lshl_b32 s14, s14, 23
    v_mul_f32 v72, s15, v32
    v_mul_f32 v73, s15, v33
    v_mov_b32 v5, s14
    v_cvt_pk_f16_f32 v44, v64, v65
    v_cvt_pk_f16_f32 v45, v68, v69
    v_cvt_pk_f16_f32 v46, v72, -v73
    v_pk_mul_f32 v[92:93], v[72:73], v[36:37] op_sel:[0,0] op_sel_hi:[1,0]
    ds_write_b32 v12, v44 offset:0
    ds_write_b32 v12, v45 offset:8448
    ds_write_b32 v13, v46 offset:0
    v_pk_fma_f32 v[92:93], v[72:73], v[36:37], v[92:93] op_sel:[1,1,0] op_sel_hi:[0,1,1] neg_lo:[1,0,0]
    v_cvt_pk_f16_f32 v47, v92, -v93
    ds_write_b32 v13, v47 offset:4224
    v_pk_mul_f32 v[66:67], v[64:65], v[38:39] op_sel:[0,0] op_sel_hi:[1,0]
    v_pk_mul_f32 v[70:71], v[68:69], v[38:39] op_sel:[0,0] op_sel_hi:[1,0]
    v_pk_mul_f32 v[74:75], v[72:73], v[34:35] op_sel:[0,0] op_sel_hi:[1,0]
    v_pk_mul_f32 v[94:95], v[92:93], v[36:37] op_sel:[0,0] op_sel_hi:[1,0]
    v_pk_fma_f32 v[66:67], v[64:65], v[38:39], v[66:67] op_sel:[1,1,0] op_sel_hi:[0,1,1] neg_lo:[1,0,0]
    v_pk_fma_f32 v[70:71], v[68:69], v[38:39], v[70:71] op_sel:[1,1,0] op_sel_hi:[0,1,1] neg_lo:[1,0,0]
    v_pk_fma_f32 v[74:75], v[72:73], v[34:35], v[74:75] op_sel:[1,1,0] op_sel_hi:[0,1,1] neg_lo:[1,0,0]
    v_pk_fma_f32 v[94:95], v[92:93], v[36:37], v[94:95] op_sel:[1,1,0] op_sel_hi:[0,1,1] neg_lo:[1,0,0]
    v_cvt_pk_f16_f32 v48, v66, v67
    v_cvt_pk_f16_f32 v49, v70, v71
    v_cvt_pk_f16_f32 v50, v74, -v75
    v_cvt_pk_f16_f32 v51, v94, -v95
    ds_write_b32 v12, v48 offset:528
    ds_write_b32 v12, v49 offset:8976
    ds_write_b32 v13, v50 offset:528
    ds_write_b32 v13, v51 offset:8448
    v_pk_mul_f32 v[64:65], v[66:67], v[38:39] op_sel:[0,0] op_sel_hi:[1,0]
    v_pk_mul_f32 v[68:69], v[70:71], v[38:39] op_sel:[0,0] op_sel_hi:[1,0]
    v_pk_mul_f32 v[76:77], v[74:75], v[34:35] op_sel:[0,0] op_sel_hi:[1,0]
    v_pk_mul_f32 v[92:93], v[94:95], v[36:37] op_sel:[0,0] op_sel_hi:[1,0]
    v_pk_fma_f32 v[64:65], v[66:67], v[38:39], v[64:65] op_sel:[1,1,0] op_sel_hi:[0,1,1] neg_lo:[1,0,0]
    v_pk_fma_f32 v[68:69], v[70:71], v[38:39], v[68:69] op_sel:[1,1,0] op_sel_hi:[0,1,1] neg_lo:[1,0,0]
    v_pk_fma_f32 v[76:77], v[74:75], v[34:35], v[76:77] op_sel:[1,1,0] op_sel_hi:[0,1,1] neg_lo:[1,0,0]
    v_pk_fma_f32 v[92:93], v[94:95], v[36:37], v[92:93] op_sel:[1,1,0] op_sel_hi:[0,1,1] neg_lo:[1,0,0]
    v_cvt_pk_f16_f32 v52, v64, v65
    v_cvt_pk_f16_f32 v53, v68, v69
    v_cvt_pk_f16_f32 v54, v76, -v77
    v_cvt_pk_f16_f32 v55, v92, -v93
    ds_write_b32 v12, v52 offset:1056
    ds_write_b32 v12, v53 offset:9504
    ds_write_b32 v13, v54 offset:1056
    ds_write_b32 v13, v55 offset:8976
    v_pk_mul_f32 v[66:67], v[64:65], v[38:39] op_sel:[0,0] op_sel_hi:[1,0]
    v_pk_mul_f32 v[70:71], v[68:69], v[38:39] op_sel:[0,0] op_sel_hi:[1,0]
    v_pk_mul_f32 v[78:79], v[76:77], v[34:35] op_sel:[0,0] op_sel_hi:[1,0]
    v_pk_mul_f32 v[94:95], v[92:93], v[36:37] op_sel:[0,0] op_sel_hi:[1,0]
    v_pk_fma_f32 v[66:67], v[64:65], v[38:39], v[66:67] op_sel:[1,1,0] op_sel_hi:[0,1,1] neg_lo:[1,0,0]
    v_pk_fma_f32 v[70:71], v[68:69], v[38:39], v[70:71] op_sel:[1,1,0] op_sel_hi:[0,1,1] neg_lo:[1,0,0]
    v_pk_fma_f32 v[78:79], v[76:77], v[34:35], v[78:79] op_sel:[1,1,0] op_sel_hi:[0,1,1] neg_lo:[1,0,0]
    v_pk_fma_f32 v[94:95], v[92:93], v[36:37], v[94:95] op_sel:[1,1,0] op_sel_hi:[0,1,1] neg_lo:[1,0,0]
    v_cvt_pk_f16_f32 v44, v66, v67
    v_cvt_pk_f16_f32 v45, v70, v71
    v_cvt_pk_f16_f32 v46, v78, -v79
    v_cvt_pk_f16_f32 v47, v94, -v95
    ds_write_b32 v12, v44 offset:1584
    ds_write_b32 v12, v45 offset:10032
    ds_write_b32 v13, v46 offset:1584
    ds_write_b32 v13, v47 offset:9504
    v_pk_mul_f32 v[64:65], v[66:67], v[38:39] op_sel:[0,0] op_sel_hi:[1,0]
    v_pk_mul_f32 v[68:69], v[70:71], v[38:39] op_sel:[0,0] op_sel_hi:[1,0]
    v_pk_mul_f32 v[80:81], v[78:79], v[34:35] op_sel:[0,0] op_sel_hi:[1,0]
    v_pk_mul_f32 v[92:93], v[94:95], v[36:37] op_sel:[0,0] op_sel_hi:[1,0]
    v_pk_fma_f32 v[64:65], v[66:67], v[38:39], v[64:65] op_sel:[1,1,0] op_sel_hi:[0,1,1] neg_lo:[1,0,0]
    v_pk_fma_f32 v[68:69], v[70:71], v[38:39], v[68:69] op_sel:[1,1,0] op_sel_hi:[0,1,1] neg_lo:[1,0,0]
    v_pk_fma_f32 v[80:81], v[78:79], v[34:35], v[80:81] op_sel:[1,1,0] op_sel_hi:[0,1,1] neg_lo:[1,0,0]
    v_pk_fma_f32 v[92:93], v[94:95], v[36:37], v[92:93] op_sel:[1,1,0] op_sel_hi:[0,1,1] neg_lo:[1,0,0]
    v_cvt_pk_f16_f32 v48, v64, v65
    v_cvt_pk_f16_f32 v49, v68, v69
    v_cvt_pk_f16_f32 v50, v80, -v81
    v_cvt_pk_f16_f32 v51, v92, -v93
    ds_write_b32 v12, v48 offset:2112
    ds_write_b32 v12, v49 offset:10560
    ds_write_b32 v13, v50 offset:2112
    ds_write_b32 v13, v51 offset:6336
    v_pk_mul_f32 v[66:67], v[64:65], v[38:39] op_sel:[0,0] op_sel_hi:[1,0]
    v_pk_mul_f32 v[70:71], v[68:69], v[38:39] op_sel:[0,0] op_sel_hi:[1,0]
    v_pk_mul_f32 v[82:83], v[80:81], v[34:35] op_sel:[0,0] op_sel_hi:[1,0]
    v_pk_mul_f32 v[94:95], v[92:93], v[36:37] op_sel:[0,0] op_sel_hi:[1,0]
    v_pk_fma_f32 v[66:67], v[64:65], v[38:39], v[66:67] op_sel:[1,1,0] op_sel_hi:[0,1,1] neg_lo:[1,0,0]
    v_pk_fma_f32 v[70:71], v[68:69], v[38:39], v[70:71] op_sel:[1,1,0] op_sel_hi:[0,1,1] neg_lo:[1,0,0]
    v_pk_fma_f32 v[82:83], v[80:81], v[34:35], v[82:83] op_sel:[1,1,0] op_sel_hi:[0,1,1] neg_lo:[1,0,0]
    v_pk_fma_f32 v[94:95], v[92:93], v[36:37], v[94:95] op_sel:[1,1,0] op_sel_hi:[0,1,1] neg_lo:[1,0,0]
    v_cvt_pk_f16_f32 v52, v66, v67
    v_cvt_pk_f16_f32 v53, v70, v71
    v_cvt_pk_f16_f32 v54, v82, -v83
    v_cvt_pk_f16_f32 v55, v94, -v95
    ds_write_b32 v12, v52 offset:2640
    ds_write_b32 v12, v53 offset:11088
    ds_write_b32 v13, v54 offset:2640
    ds_write_b32 v13, v55 offset:6864
    v_pk_mul_f32 v[64:65], v[66:67], v[38:39] op_sel:[0,0] op_sel_hi:[1,0]
    v_pk_mul_f32 v[68:69], v[70:71], v[38:39] op_sel:[0,0] op_sel_hi:[1,0]
    v_pk_mul_f32 v[84:85], v[82:83], v[34:35] op_sel:[0,0] op_sel_hi:[1,0]
    v_pk_mul_f32 v[92:93], v[94:95], v[36:37] op_sel:[0,0] op_sel_hi:[1,0]
    v_pk_fma_f32 v[64:65], v[66:67], v[38:39], v[64:65] op_sel:[1,1,0] op_sel_hi:[0,1,1] neg_lo:[1,0,0]
    v_pk_fma_f32 v[68:69], v[70:71], v[38:39], v[68:69] op_sel:[1,1,0] op_sel_hi:[0,1,1] neg_lo:[1,0,0]
    v_pk_fma_f32 v[84:85], v[82:83], v[34:35], v[84:85] op_sel:[1,1,0] op_sel_hi:[0,1,1] neg_lo:[1,0,0]
    v_pk_fma_f32 v[92:93], v[94:95], v[36:37], v[92:93] op_sel:[1,1,0] op_sel_hi:[0,1,1] neg_lo:[1,0,0]
    v_cvt_pk_f16_f32 v44, v64, v65
    v_cvt_pk_f16_f32 v45, v68, v69
    v_cvt_pk_f16_f32 v46, v84, -v85
    v_cvt_pk_f16_f32 v47, v92, -v93
    ds_write_b32 v12, v44 offset:3168
    ds_write_b32 v12, v45 offset:11616
    ds_write_b32 v13, v46 offset:3168
    ds_write_b32 v13, v47 offset:7392
    v_pk_mul_f32 v[66:67], v[64:65], v[38:39] op_sel:[0,0] op_sel_hi:[1,0]
    v_pk_mul_f32 v[70:71], v[68:69], v[38:39] op_sel:[0,0] op_sel_hi:[1,0]
    v_pk_mul_f32 v[86:87], v[84:85], v[34:35] op_sel:[0,0] op_sel_hi:[1,0]
    v_pk_mul_f32 v[94:95], v[92:93], v[36:37] op_sel:[0,0] op_sel_hi:[1,0]
    v_pk_fma_f32 v[66:67], v[64:65], v[38:39], v[66:67] op_sel:[1,1,0] op_sel_hi:[0,1,1] neg_lo:[1,0,0]
    v_pk_fma_f32 v[70:71], v[68:69], v[38:39], v[70:71] op_sel:[1,1,0] op_sel_hi:[0,1,1] neg_lo:[1,0,0]
    v_pk_fma_f32 v[86:87], v[84:85], v[34:35], v[86:87] op_sel:[1,1,0] op_sel_hi:[0,1,1] neg_lo:[1,0,0]
    v_pk_fma_f32 v[94:95], v[92:93], v[36:37], v[94:95] op_sel:[1,1,0] op_sel_hi:[0,1,1] neg_lo:[1,0,0]
    v_cvt_pk_f16_f32 v48, v66, v67
    v_cvt_pk_f16_f32 v49, v70, v71
    v_cvt_pk_f16_f32 v50, v86, -v87
    v_cvt_pk_f16_f32 v51, v94, -v95
    ds_write_b32 v12, v48 offset:3696
    ds_write_b32 v12, v49 offset:12144
    ds_write_b32 v13, v50 offset:3696
    ds_write_b32 v13, v51 offset:7920
    v_pk_mul_f32 v[64:65], v[66:67], v[38:39] op_sel:[0,0] op_sel_hi:[1,0]
    v_pk_mul_f32 v[68:69], v[70:71], v[38:39] op_sel:[0,0] op_sel_hi:[1,0]
    v_pk_mul_f32 v[82:83], v[80:81], v[36:37] op_sel:[0,0] op_sel_hi:[1,0]
    v_pk_fma_f32 v[64:65], v[66:67], v[38:39], v[64:65] op_sel:[1,1,0] op_sel_hi:[0,1,1] neg_lo:[1,0,0]
    v_pk_fma_f32 v[68:69], v[70:71], v[38:39], v[68:69] op_sel:[1,1,0] op_sel_hi:[0,1,1] neg_lo:[1,0,0]
    v_pk_fma_f32 v[82:83], v[80:81], v[36:37], v[82:83] op_sel:[1,1,0] op_sel_hi:[0,1,1] neg_lo:[1,0,0]
    v_cvt_pk_f16_f32 v52, v64, v65
    v_cvt_pk_f16_f32 v53, v68, v69
    v_cvt_pk_f16_f32 v54, v82, -v83
    ds_write_b32 v12, v52 offset:4224
    ds_write_b32 v12, v53 offset:12672
    ds_write_b32 v13, v54 offset:5280
    v_pk_mul_f32 v[66:67], v[64:65], v[38:39] op_sel:[0,0] op_sel_hi:[1,0]
    v_pk_mul_f32 v[70:71], v[68:69], v[38:39] op_sel:[0,0] op_sel_hi:[1,0]
    v_pk_mul_f32 v[80:81], v[82:83], v[36:37] op_sel:[0,0] op_sel_hi:[1,0]
    v_pk_fma_f32 v[66:67], v[64:65], v[38:39], v[66:67] op_sel:[1,1,0] op_sel_hi:[0,1,1] neg_lo:[1,0,0]
    v_pk_fma_f32 v[70:71], v[68:69], v[38:39], v[70:71] op_sel:[1,1,0] op_sel_hi:[0,1,1] neg_lo:[1,0,0]
    v_pk_fma_f32 v[80:81], v[82:83], v[36:37], v[80:81] op_sel:[1,1,0] op_sel_hi:[0,1,1] neg_lo:[1,0,0]
    v_cvt_pk_f16_f32 v55, v66, v67
    v_cvt_pk_f16_f32 v44, v70, v71
    v_cvt_pk_f16_f32 v45, v80, -v81
    ds_write_b32 v12, v55 offset:4752
    ds_write_b32 v12, v44 offset:13200
    ds_write_b32 v13, v45 offset:10032
    v_pk_mul_f32 v[64:65], v[66:67], v[38:39] op_sel:[0,0] op_sel_hi:[1,0]
    v_pk_mul_f32 v[68:69], v[70:71], v[38:39] op_sel:[0,0] op_sel_hi:[1,0]
    v_pk_mul_f32 v[82:83], v[80:81], v[36:37] op_sel:[0,0] op_sel_hi:[1,0]
    v_pk_fma_f32 v[64:65], v[66:67], v[38:39], v[64:65] op_sel:[1,1,0] op_sel_hi:[0,1,1] neg_lo:[1,0,0]
    v_pk_fma_f32 v[68:69], v[70:71], v[38:39], v[68:69] op_sel:[1,1,0] op_sel_hi:[0,1,1] neg_lo:[1,0,0]
    v_pk_fma_f32 v[82:83], v[80:81], v[36:37], v[82:83] op_sel:[1,1,0] op_sel_hi:[0,1,1] neg_lo:[1,0,0]
    v_cvt_pk_f16_f32 v46, v64, v65
    v_cvt_pk_f16_f32 v47, v68, v69
    v_cvt_pk_f16_f32 v48, v82, -v83
    ds_write_b32 v12, v46 offset:5280
    ds_write_b32 v12, v47 offset:13728
    ds_write_b32 v13, v48 offset:10560
    v_pk_mul_f32 v[66:67], v[64:65], v[38:39] op_sel:[0,0] op_sel_hi:[1,0]
    v_pk_mul_f32 v[70:71], v[68:69], v[38:39] op_sel:[0,0] op_sel_hi:[1,0]
    v_pk_mul_f32 v[78:79], v[76:77], v[36:37] op_sel:[0,0] op_sel_hi:[1,0]
    v_pk_fma_f32 v[66:67], v[64:65], v[38:39], v[66:67] op_sel:[1,1,0] op_sel_hi:[0,1,1] neg_lo:[1,0,0]
    v_pk_fma_f32 v[70:71], v[68:69], v[38:39], v[70:71] op_sel:[1,1,0] op_sel_hi:[0,1,1] neg_lo:[1,0,0]
    v_pk_fma_f32 v[78:79], v[76:77], v[36:37], v[78:79] op_sel:[1,1,0] op_sel_hi:[0,1,1] neg_lo:[1,0,0]
    v_cvt_pk_f16_f32 v49, v66, v67
    v_cvt_pk_f16_f32 v50, v70, v71
    v_cvt_pk_f16_f32 v51, v78, -v79
    ds_write_b32 v12, v49 offset:5808
    ds_write_b32 v12, v50 offset:14256
    ds_write_b32 v13, v51 offset:4752
    v_pk_mul_f32 v[64:65], v[66:67], v[38:39] op_sel:[0,0] op_sel_hi:[1,0]
    v_pk_mul_f32 v[68:69], v[70:71], v[38:39] op_sel:[0,0] op_sel_hi:[1,0]
    v_pk_mul_f32 v[86:87], v[84:85], v[36:37] op_sel:[0,0] op_sel_hi:[1,0]
    v_pk_fma_f32 v[64:65], v[66:67], v[38:39], v[64:65] op_sel:[1,1,0] op_sel_hi:[0,1,1] neg_lo:[1,0,0]
    v_pk_fma_f32 v[68:69], v[70:71], v[38:39], v[68:69] op_sel:[1,1,0] op_sel_hi:[0,1,1] neg_lo:[1,0,0]
    v_pk_fma_f32 v[86:87], v[84:85], v[36:37], v[86:87] op_sel:[1,1,0] op_sel_hi:[0,1,1] neg_lo:[1,0,0]
    v_cvt_pk_f16_f32 v52, v64, v65
    v_cvt_pk_f16_f32 v53, v68, v69
    v_cvt_pk_f16_f32 v54, v86, -v87
    ds_write_b32 v12, v52 offset:6336
    ds_write_b32 v12, v53 offset:14784
    ds_write_b32 v13, v54 offset:5808
    v_pk_mul_f32 v[66:67], v[64:65], v[38:39] op_sel:[0,0] op_sel_hi:[1,0]
    v_pk_mul_f32 v[70:71], v[68:69], v[38:39] op_sel:[0,0] op_sel_hi:[1,0]
    v_pk_fma_f32 v[66:67], v[64:65], v[38:39], v[66:67] op_sel:[1,1,0] op_sel_hi:[0,1,1] neg_lo:[1,0,0]
    v_pk_fma_f32 v[70:71], v[68:69], v[38:39], v[70:71] op_sel:[1,1,0] op_sel_hi:[0,1,1] neg_lo:[1,0,0]
    v_cvt_pk_f16_f32 v55, v66, v67
    v_cvt_pk_f16_f32 v44, v70, v71
    ds_write_b32 v12, v55 offset:6864
    ds_write_b32 v12, v44 offset:15312
    v_pk_mul_f32 v[64:65], v[66:67], v[38:39] op_sel:[0,0] op_sel_hi:[1,0]
    v_pk_mul_f32 v[68:69], v[70:71], v[38:39] op_sel:[0,0] op_sel_hi:[1,0]
    v_pk_fma_f32 v[64:65], v[66:67], v[38:39], v[64:65] op_sel:[1,1,0] op_sel_hi:[0,1,1] neg_lo:[1,0,0]
    v_pk_fma_f32 v[68:69], v[70:71], v[38:39], v[68:69] op_sel:[1,1,0] op_sel_hi:[0,1,1] neg_lo:[1,0,0]
    v_cvt_pk_f16_f32 v45, v64, v65
    v_cvt_pk_f16_f32 v46, v68, v69
    ds_write_b32 v12, v45 offset:7392
    ds_write_b32 v12, v46 offset:15840
    v_pk_mul_f32 v[66:67], v[64:65], v[38:39] op_sel:[0,0] op_sel_hi:[1,0]
    v_pk_mul_f32 v[70:71], v[68:69], v[38:39] op_sel:[0,0] op_sel_hi:[1,0]
    v_pk_fma_f32 v[66:67], v[64:65], v[38:39], v[66:67] op_sel:[1,1,0] op_sel_hi:[0,1,1] neg_lo:[1,0,0]
    v_pk_fma_f32 v[70:71], v[68:69], v[38:39], v[70:71] op_sel:[1,1,0] op_sel_hi:[0,1,1] neg_lo:[1,0,0]
    v_cvt_pk_f16_f32 v47, v66, v67
    v_cvt_pk_f16_f32 v48, v70, v71
    ds_write_b32 v12, v47 offset:7920
    ds_write_b32 v12, v48 offset:16368
    s_mov_b64 exec, 1
    ds_write_b32 v4, v5
    s_mov_b64 exec, -1
    s_lshl_b32 s13, s97, 11
    s_lshl_b32 s14, s96, 3
    s_add_u32 s13, s13, s14
    s_add_u32 s13, s13, 114688
    v_add_u32 v20, s13, v1
    v_xor_b32 v21, 8, v20
    s_waitcnt lgkmcnt(0)
    s_barrier
    s_setprio 2
    ds_read_b128 v[32:35], v2 offset:0
    ds_read_b64_tr_b16 v[48:49], v8 offset:0
    ds_read_b64_tr_b16 v[50:51], v8 offset:512
    ds_read_b64_tr_b16 v[52:53], v8 offset:8192
    ds_read_b64_tr_b16 v[54:55], v8 offset:8704
    ds_read_b128 v[36:39], v2 offset:2048
    ds_read_b64_tr_b16 v[56:57], v9 offset:0
    ds_read_b64_tr_b16 v[58:59], v9 offset:512
    ds_read_b64_tr_b16 v[60:61], v9 offset:8192
    ds_read_b64_tr_b16 v[62:63], v9 offset:8704
    ds_read_b128 v[40:43], v2 offset:4096
    ds_read_b64_tr_b16 v[64:65], v10 offset:0
    ds_read_b64_tr_b16 v[66:67], v10 offset:512
    ds_read_b64_tr_b16 v[68:69], v10 offset:8192
    ds_read_b64_tr_b16 v[70:71], v10 offset:8704
    ds_read_b128 v[44:47], v2 offset:6144
    ds_read_b64_tr_b16 v[72:73], v11 offset:0
    ds_read_b64_tr_b16 v[74:75], v11 offset:512
    ds_read_b64_tr_b16 v[76:77], v11 offset:8192
    ds_read_b64_tr_b16 v[78:79], v11 offset:8704
    ds_read_b64_tr_b16 v[4:5], v125 offset:0
    ds_read_b64_tr_b16 v[6:7], v125 offset:4352
    ds_read_b64_tr_b16 v[12:13], v125 offset:128
    ds_read_b64_tr_b16 v[14:15], v125 offset:4480
    ds_read_b32 v28, v124
    ds_read_b32 v30, v124 offset:4
    s_cmp_ge_u32 s5, 28
    s_cbranch_scc1 L_spare
    s_waitcnt lgkmcnt(0)
    v_mfma_f32_16x16x32_bf16 v[128:131], v[48:51], v[32:35], 0
    v_mfma_f32_16x16x32_bf16 v[132:135], v[48:51], v[36:39], 0
    s_barrier
    v_mfma_f32_16x16x32_bf16 v[136:139], v[48:51], v[40:43], 0
    ds_read_b128 v[80:83], v3 offset:0
    v_mfma_f32_16x16x32_bf16 v[140:143], v[48:51], v[44:47], 0
    ds_read_b64_tr_b16 v[96:97], v8 offset:16384
    v_mfma_f32_16x16x32_bf16 v[144:147], v[52:55], v[32:35], 0
    ds_read_b64_tr_b16 v[98:99], v8 offset:16896
    v_mfma_f32_16x16x32_bf16 v[148:151], v[52:55], v[36:39], 0
    ds_read_b64_tr_b16 v[100:101], v8 offset:24576
    v_mfma_f32_16x16x32_bf16 v[152:155], v[52:55], v[40:43], 0
    ds_read_b64_tr_b16 v[102:103], v8 offset:25088
    v_mfma_f32_16x16x32_bf16 v[156:159], v[52:55], v[44:47], 0
    ds_read_b128 v[84:87], v3 offset:2048
    v_mfma_f32_16x16x32_bf16 v[160:163], v[56:59], v[32:35], 0
    ds_read_b64_tr_b16 v[104:105], v9 offset:16384
    v_mfma_f32_16x16x32_bf16 v[164:167], v[56:59], v[36:39], 0
    ds_read_b64_tr_b16 v[106:107], v9 offset:16896
    v_mfma_f32_16x16x32_bf16 v[168:171], v[56:59], v[40:43], 0
    ds_read_b64_tr_b16 v[108:109], v9 offset:24576
    v_mfma_f32_16x16x32_bf16 v[172:175], v[56:59], v[44:47], 0
    ds_read_b64_tr_b16 v[110:111], v9 offset:25088
    v_mfma_f32_16x16x32_bf16 v[176:179], v[60:63], v[32:35], 0
    ds_read_b128 v[88:91], v3 offset:4096
    v_mfma_f32_16x16x32_bf16 v[180:183], v[60:63], v[36:39], 0
    ds_read_b64_tr_b16 v[112:113], v10 offset:16384
    v_mfma_f32_16x16x32_bf16 v[184:187], v[60:63], v[40:43], 0
    ds_read_b64_tr_b16 v[114:115], v10 offset:16896
    v_mfma_f32_16x16x32_bf16 v[188:191], v[60:63], v[44:47], 0
    ds_read_b64_tr_b16 v[116:117], v10 offset:24576
    v_mfma_f32_16x16x32_bf16 v[192:195], v[64:67], v[32:35], 0
    ds_read_b64_tr_b16 v[118:119], v10 offset:25088
    v_mfma_f32_16x16x32_bf16 v[196:199], v[64:67], v[36:39], 0
    ds_read_b128 v[92:95], v3 offset:6144
    v_mfma_f32_16x16x32_bf16 v[200:203], v[64:67], v[40:43], 0
    ds_read_b64_tr_b16 v[120:121], v11 offset:16384
    v_mfma_f32_16x16x32_bf16 v[204:207], v[64:67], v[44:47], 0
    ds_read_b64_tr_b16 v[122:123], v11 offset:16896
    v_mfma_f32_16x16x32_bf16 v[208:211], v[68:71], v[32:35], 0
    ds_read_b64_tr_b16 v[124:125], v11 offset:24576
    v_mfma_f32_16x16x32_bf16 v[212:215], v[68:71], v[36:39], 0
    ds_read_b64_tr_b16 v[126:127], v11 offset:25088
    v_mfma_f32_16x16x32_bf16 v[216:219], v[68:71], v[40:43], 0
    v_mfma_f32_16x16x32_bf16 v[220:223], v[68:71], v[44:47], 0
    v_mfma_f32_16x16x32_bf16 v[224:227], v[72:75], v[32:35], 0
    v_mfma_f32_16x16x32_bf16 v[228:231], v[72:75], v[36:39], 0
    v_mfma_f32_16x16x32_bf16 v[232:235], v[72:75], v[40:43], 0
    v_mfma_f32_16x16x32_bf16 v[236:239], v[72:75], v[44:47], 0
    v_mfma_f32_16x16x32_bf16 v[240:243], v[76:79], v[32:35], 0
    v_mfma_f32_16x16x32_bf16 v[244:247], v[76:79], v[36:39], 0
    v_mfma_f32_16x16x32_bf16 v[248:251], v[76:79], v[40:43], 0
    v_mfma_f32_16x16x32_bf16 v[252:255], v[76:79], v[44:47], 0
    s_waitcnt lgkmcnt(0)
    v_mfma_f32_16x16x32_bf16 v[128:131], v[96:99], v[80:83], v[128:131]
    v_mfma_f32_16x16x32_bf16 v[132:135], v[96:99], v[84:87], v[132:135]
    s_barrier
    v_mfma_f32_16x16x32_bf16 v[136:139], v[96:99], v[88:91], v[136:139]
    ds_read_b128 v[32:35], v2 offset:16384
    v_mfma_f32_16x16x32_bf16 v[140:143], v[96:99], v[92:95], v[140:143]
    ds_read_b64_tr_b16 v[48:49], v8 offset:32768
    v_mfma_f32_16x16x32_bf16 v[144:147], v[100:103], v[80:83], v[144:147]
    ds_read_b64_tr_b16 v[50:51], v8 offset:33280
    v_mfma_f32_16x16x32_bf16 v[148:151], v[100:103], v[84:87], v[148:151]
    ds_read_b64_tr_b16 v[52:53], v8 offset:40960
    v_mfma_f32_16x16x32_bf16 v[152:155], v[100:103], v[88:91], v[152:155]
    ds_read_b64_tr_b16 v[54:55], v8 offset:41472
    v_mfma_f32_16x16x32_bf16 v[156:159], v[100:103], v[92:95], v[156:159]
    ds_read_b128 v[36:39], v2 offset:18432
    v_mfma_f32_16x16x32_bf16 v[160:163], v[104:107], v[80:83], v[160:163]
    ds_read_b64_tr_b16 v[56:57], v9 offset:32768
    v_mfma_f32_16x16x32_bf16 v[164:167], v[104:107], v[84:87], v[164:167]
    ds_read_b64_tr_b16 v[58:59], v9 offset:33280
    v_mfma_f32_16x16x32_bf16 v[168:171], v[104:107], v[88:91], v[168:171]
    ds_read_b64_tr_b16 v[60:61], v9 offset:40960
    v_mfma_f32_16x16x32_bf16 v[172:175], v[104:107], v[92:95], v[172:175]
    ds_read_b64_tr_b16 v[62:63], v9 offset:41472
    v_mfma_f32_16x16x32_bf16 v[176:179], v[108:111], v[80:83], v[176:179]
    ds_read_b128 v[40:43], v2 offset:20480
    v_mfma_f32_16x16x32_bf16 v[180:183], v[108:111], v[84:87], v[180:183]
    ds_read_b64_tr_b16 v[64:65], v10 offset:32768
    v_mfma_f32_16x16x32_bf16 v[184:187], v[108:111], v[88:91], v[184:187]
    ds_read_b64_tr_b16 v[66:67], v10 offset:33280
    v_mfma_f32_16x16x32_bf16 v[188:191], v[108:111], v[92:95], v[188:191]
    ds_read_b64_tr_b16 v[68:69], v10 offset:40960
    v_mfma_f32_16x16x32_bf16 v[192:195], v[112:115], v[80:83], v[192:195]
    ds_read_b64_tr_b16 v[70:71], v10 offset:41472
    v_mfma_f32_16x16x32_bf16 v[196:199], v[112:115], v[84:87], v[196:199]
    ds_read_b128 v[44:47], v2 offset:22528
    v_mfma_f32_16x16x32_bf16 v[200:203], v[112:115], v[88:91], v[200:203]
    ds_read_b64_tr_b16 v[72:73], v11 offset:32768
    v_mfma_f32_16x16x32_bf16 v[204:207], v[112:115], v[92:95], v[204:207]
    ds_read_b64_tr_b16 v[74:75], v11 offset:33280
    v_mfma_f32_16x16x32_bf16 v[208:211], v[116:119], v[80:83], v[208:211]
    ds_read_b64_tr_b16 v[76:77], v11 offset:40960
    v_mfma_f32_16x16x32_bf16 v[212:215], v[116:119], v[84:87], v[212:215]
    ds_read_b64_tr_b16 v[78:79], v11 offset:41472
    v_mfma_f32_16x16x32_bf16 v[216:219], v[116:119], v[88:91], v[216:219]
    v_mov_b32 v19, 163832
    v_mfma_f32_16x16x32_bf16 v[220:223], v[116:119], v[92:95], v[220:223]
    ds_read_b32 v29, v19
    v_mfma_f32_16x16x32_bf16 v[224:227], v[120:123], v[80:83], v[224:227]
    ds_read_b32 v31, v19
    v_mfma_f32_16x16x32_bf16 v[228:231], v[120:123], v[84:87], v[228:231]
    buffer_store_dwordx4 v[4:7], v1, s[68:71], s92 offen sc1
    v_mfma_f32_16x16x32_bf16 v[232:235], v[120:123], v[88:91], v[232:235]
    v_mfma_f32_16x16x32_bf16 v[236:239], v[120:123], v[92:95], v[236:239]
    v_mfma_f32_16x16x32_bf16 v[240:243], v[124:127], v[80:83], v[240:243]
    v_mfma_f32_16x16x32_bf16 v[244:247], v[124:127], v[84:87], v[244:247]
    v_mfma_f32_16x16x32_bf16 v[248:251], v[124:127], v[88:91], v[248:251]
    v_mfma_f32_16x16x32_bf16 v[252:255], v[124:127], v[92:95], v[252:255]
    s_waitcnt lgkmcnt(0)
    v_mfma_f32_16x16x32_bf16 v[128:131], v[48:51], v[32:35], v[128:131]
    v_mfma_f32_16x16x32_bf16 v[132:135], v[48:51], v[36:39], v[132:135]
    s_barrier
    v_mfma_f32_16x16x32_bf16 v[136:139], v[48:51], v[40:43], v[136:139]
    ds_read_b128 v[80:83], v3 offset:16384
    v_mfma_f32_16x16x32_bf16 v[140:143], v[48:51], v[44:47], v[140:143]
    ds_read_b64_tr_b16 v[96:97], v8 offset:49152
    v_mfma_f32_16x16x32_bf16 v[144:147], v[52:55], v[32:35], v[144:147]
    ds_read_b64_tr_b16 v[98:99], v8 offset:49664
    v_mfma_f32_16x16x32_bf16 v[148:151], v[52:55], v[36:39], v[148:151]
    ds_read_b64_tr_b16 v[100:101], v8 offset:57344
    v_mfma_f32_16x16x32_bf16 v[152:155], v[52:55], v[40:43], v[152:155]
    ds_read_b64_tr_b16 v[102:103], v8 offset:57856
    v_mfma_f32_16x16x32_bf16 v[156:159], v[52:55], v[44:47], v[156:159]
    ds_read_b128 v[84:87], v3 offset:18432
    v_mfma_f32_16x16x32_bf16 v[160:163], v[56:59], v[32:35], v[160:163]
    ds_read_b64_tr_b16 v[104:105], v9 offset:49152
    v_mfma_f32_16x16x32_bf16 v[164:167], v[56:59], v[36:39], v[164:167]
    ds_read_b64_tr_b16 v[106:107], v9 offset:49664
    v_mfma_f32_16x16x32_bf16 v[168:171], v[56:59], v[40:43], v[168:171]
    ds_read_b64_tr_b16 v[108:109], v9 offset:57344
    v_mfma_f32_16x16x32_bf16 v[172:175], v[56:59], v[44:47], v[172:175]
    ds_read_b64_tr_b16 v[110:111], v9 offset:57856
    v_mfma_f32_16x16x32_bf16 v[176:179], v[60:63], v[32:35], v[176:179]
    ds_read_b128 v[88:91], v3 offset:20480
    v_mfma_f32_16x16x32_bf16 v[180:183], v[60:63], v[36:39], v[180:183]
    ds_read_b64_tr_b16 v[112:113], v10 offset:49152
    v_mfma_f32_16x16x32_bf16 v[184:187], v[60:63], v[40:43], v[184:187]
    ds_read_b64_tr_b16 v[114:115], v10 offset:49664
    v_mfma_f32_16x16x32_bf16 v[188:191], v[60:63], v[44:47], v[188:191]
    ds_read_b64_tr_b16 v[116:117], v10 offset:57344
    v_mfma_f32_16x16x32_bf16 v[192:195], v[64:67], v[32:35], v[192:195]
    ds_read_b64_tr_b16 v[118:119], v10 offset:57856
    v_mfma_f32_16x16x32_bf16 v[196:199], v[64:67], v[36:39], v[196:199]
    ds_read_b128 v[92:95], v3 offset:22528
    v_mfma_f32_16x16x32_bf16 v[200:203], v[64:67], v[40:43], v[200:203]
    ds_read_b64_tr_b16 v[120:121], v11 offset:49152
    v_mfma_f32_16x16x32_bf16 v[204:207], v[64:67], v[44:47], v[204:207]
    ds_read_b64_tr_b16 v[122:123], v11 offset:49664
    v_mfma_f32_16x16x32_bf16 v[208:211], v[68:71], v[32:35], v[208:211]
    ds_read_b64_tr_b16 v[124:125], v11 offset:57344
    v_mfma_f32_16x16x32_bf16 v[212:215], v[68:71], v[36:39], v[212:215]
    ds_read_b64_tr_b16 v[126:127], v11 offset:57856
    v_mfma_f32_16x16x32_bf16 v[216:219], v[68:71], v[40:43], v[216:219]
    buffer_store_dwordx4 v[12:15], v1, s[68:71], s92 offen offset:1024 sc1
    v_mfma_f32_16x16x32_bf16 v[220:223], v[68:71], v[44:47], v[220:223]
    v_readfirstlane_b32 s89, v29
    v_mfma_f32_16x16x32_bf16 v[224:227], v[72:75], v[32:35], v[224:227]
    s_mov_b64 exec, 3
    buffer_store_dwordx4 v[28:31], v1, s[68:71], s94 offen sc1
    s_mov_b64 exec, -1
    v_mfma_f32_16x16x32_bf16 v[228:231], v[72:75], v[36:39], v[228:231]
    v_mfma_f32_16x16x32_bf16 v[232:235], v[72:75], v[40:43], v[232:235]
    v_mfma_f32_16x16x32_bf16 v[236:239], v[72:75], v[44:47], v[236:239]
    v_mfma_f32_16x16x32_bf16 v[240:243], v[76:79], v[32:35], v[240:243]
    v_mfma_f32_16x16x32_bf16 v[244:247], v[76:79], v[36:39], v[244:247]
    v_mfma_f32_16x16x32_bf16 v[248:251], v[76:79], v[40:43], v[248:251]
    v_mfma_f32_16x16x32_bf16 v[252:255], v[76:79], v[44:47], v[252:255]
    s_waitcnt lgkmcnt(0)
    v_mfma_f32_16x16x32_bf16 v[128:131], v[96:99], v[80:83], v[128:131]
    v_mfma_f32_16x16x32_bf16 v[132:135], v[96:99], v[84:87], v[132:135]
    s_barrier
    v_mfma_f32_16x16x32_bf16 v[136:139], v[96:99], v[88:91], v[136:139]
    ds_read_b128 v[32:35], v2 offset:32768
    v_mfma_f32_16x16x32_bf16 v[140:143], v[96:99], v[92:95], v[140:143]
    ds_read_b64_tr_b16 v[48:49], v8 offset:0
    v_mfma_f32_16x16x32_bf16 v[144:147], v[100:103], v[80:83], v[144:147]
    ds_read_b64_tr_b16 v[50:51], v8 offset:512
    v_mfma_f32_16x16x32_bf16 v[148:151], v[100:103], v[84:87], v[148:151]
    ds_read_b64_tr_b16 v[52:53], v8 offset:8192
    v_mfma_f32_16x16x32_bf16 v[152:155], v[100:103], v[88:91], v[152:155]
    ds_read_b64_tr_b16 v[54:55], v8 offset:8704
    v_mfma_f32_16x16x32_bf16 v[156:159], v[100:103], v[92:95], v[156:159]
    ds_read_b128 v[36:39], v2 offset:34816
    v_mfma_f32_16x16x32_bf16 v[160:163], v[104:107], v[80:83], v[160:163]
    ds_read_b64_tr_b16 v[56:57], v9 offset:0
    v_mfma_f32_16x16x32_bf16 v[164:167], v[104:107], v[84:87], v[164:167]
    ds_read_b64_tr_b16 v[58:59], v9 offset:512
    v_mfma_f32_16x16x32_bf16 v[168:171], v[104:107], v[88:91], v[168:171]
    ds_read_b64_tr_b16 v[60:61], v9 offset:8192
    v_mfma_f32_16x16x32_bf16 v[172:175], v[104:107], v[92:95], v[172:175]
    ds_read_b64_tr_b16 v[62:63], v9 offset:8704
    v_mfma_f32_16x16x32_bf16 v[176:179], v[108:111], v[80:83], v[176:179]
    ds_read_b128 v[40:43], v2 offset:36864
    v_mfma_f32_16x16x32_bf16 v[180:183], v[108:111], v[84:87], v[180:183]
    ds_read_b64_tr_b16 v[64:65], v10 offset:0
    v_mfma_f32_16x16x32_bf16 v[184:187], v[108:111], v[88:91], v[184:187]
    ds_read_b64_tr_b16 v[66:67], v10 offset:512
    v_mfma_f32_16x16x32_bf16 v[188:191], v[108:111], v[92:95], v[188:191]
    ds_read_b64_tr_b16 v[68:69], v10 offset:8192
    v_mfma_f32_16x16x32_bf16 v[192:195], v[112:115], v[80:83], v[192:195]
    ds_read_b64_tr_b16 v[70:71], v10 offset:8704
    v_mfma_f32_16x16x32_bf16 v[196:199], v[112:115], v[84:87], v[196:199]
    ds_read_b128 v[44:47], v2 offset:38912
    v_mfma_f32_16x16x32_bf16 v[200:203], v[112:115], v[88:91], v[200:203]
    ds_read_b64_tr_b16 v[72:73], v11 offset:0
    v_mfma_f32_16x16x32_bf16 v[204:207], v[112:115], v[92:95], v[204:207]
    ds_read_b64_tr_b16 v[74:75], v11 offset:512
    v_mfma_f32_16x16x32_bf16 v[208:211], v[116:119], v[80:83], v[208:211]
    ds_read_b64_tr_b16 v[76:77], v11 offset:8192
    v_mfma_f32_16x16x32_bf16 v[212:215], v[116:119], v[84:87], v[212:215]
    ds_read_b64_tr_b16 v[78:79], v11 offset:8704
    v_mfma_f32_16x16x32_bf16 v[216:219], v[116:119], v[88:91], v[216:219]
    v_mov_b32 v4, -1
    v_mfma_f32_16x16x32_bf16 v[220:223], v[116:119], v[92:95], v[220:223]
    v_mov_b32 v5, -1
    v_mfma_f32_16x16x32_bf16 v[224:227], v[120:123], v[80:83], v[224:227]
    v_mov_b32 v6, -1
    v_mfma_f32_16x16x32_bf16 v[228:231], v[120:123], v[84:87], v[228:231]
    v_mov_b32 v7, -1
    v_mfma_f32_16x16x32_bf16 v[232:235], v[120:123], v[88:91], v[232:235]
    buffer_store_dwordx4 v[4:7], v1, s[68:71], s95 offen sc1
    v_mfma_f32_16x16x32_bf16 v[236:239], v[120:123], v[92:95], v[236:239]
    v_mfma_f32_16x16x32_bf16 v[240:243], v[124:127], v[80:83], v[240:243]
    v_mfma_f32_16x16x32_bf16 v[244:247], v[124:127], v[84:87], v[244:247]
    v_mfma_f32_16x16x32_bf16 v[248:251], v[124:127], v[88:91], v[248:251]
    v_mfma_f32_16x16x32_bf16 v[252:255], v[124:127], v[92:95], v[252:255]
    s_waitcnt lgkmcnt(0)
    v_mfma_f32_16x16x32_bf16 v[128:131], v[48:51], v[32:35], v[128:131]
    v_mfma_f32_16x16x32_bf16 v[132:135], v[48:51], v[36:39], v[132:135]
    s_barrier
    v_mfma_f32_16x16x32_bf16 v[136:139], v[48:51], v[40:43], v[136:139]
    ds_read_b128 v[80:83], v3 offset:32768
    v_mfma_f32_16x16x32_bf16 v[140:143], v[48:51], v[44:47], v[140:143]
    ds_read_b64_tr_b16 v[96:97], v8 offset:16384
    v_mfma_f32_16x16x32_bf16 v[144:147], v[52:55], v[32:35], v[144:147]
    ds_read_b64_tr_b16 v[98:99], v8 offset:16896
    v_mfma_f32_16x16x32_bf16 v[148:151], v[52:55], v[36:39], v[148:151]
    ds_read_b64_tr_b16 v[100:101], v8 offset:24576
    v_mfma_f32_16x16x32_bf16 v[152:155], v[52:55], v[40:43], v[152:155]
    ds_read_b64_tr_b16 v[102:103], v8 offset:25088
    v_mfma_f32_16x16x32_bf16 v[156:159], v[52:55], v[44:47], v[156:159]
    ds_read_b128 v[84:87], v3 offset:34816
    v_mfma_f32_16x16x32_bf16 v[160:163], v[56:59], v[32:35], v[160:163]
    ds_read_b64_tr_b16 v[104:105], v9 offset:16384
    v_mfma_f32_16x16x32_bf16 v[164:167], v[56:59], v[36:39], v[164:167]
    ds_read_b64_tr_b16 v[106:107], v9 offset:16896
    v_mfma_f32_16x16x32_bf16 v[168:171], v[56:59], v[40:43], v[168:171]
    ds_read_b64_tr_b16 v[108:109], v9 offset:24576
    v_mfma_f32_16x16x32_bf16 v[172:175], v[56:59], v[44:47], v[172:175]
    ds_read_b64_tr_b16 v[110:111], v9 offset:25088
    v_mfma_f32_16x16x32_bf16 v[176:179], v[60:63], v[32:35], v[176:179]
    ds_read_b128 v[88:91], v3 offset:36864
    v_mfma_f32_16x16x32_bf16 v[180:183], v[60:63], v[36:39], v[180:183]
    ds_read_b64_tr_b16 v[112:113], v10 offset:16384
    v_mfma_f32_16x16x32_bf16 v[184:187], v[60:63], v[40:43], v[184:187]
    ds_read_b64_tr_b16 v[114:115], v10 offset:16896
    v_mfma_f32_16x16x32_bf16 v[188:191], v[60:63], v[44:47], v[188:191]
    ds_read_b64_tr_b16 v[116:117], v10 offset:24576
    v_mfma_f32_16x16x32_bf16 v[192:195], v[64:67], v[32:35], v[192:195]
    ds_read_b64_tr_b16 v[118:119], v10 offset:25088
    v_mfma_f32_16x16x32_bf16 v[196:199], v[64:67], v[36:39], v[196:199]
    ds_read_b128 v[92:95], v3 offset:38912
    v_mfma_f32_16x16x32_bf16 v[200:203], v[64:67], v[40:43], v[200:203]
    ds_read_b64_tr_b16 v[120:121], v11 offset:16384
    v_mfma_f32_16x16x32_bf16 v[204:207], v[64:67], v[44:47], v[204:207]
    ds_read_b64_tr_b16 v[122:123], v11 offset:16896
    v_mfma_f32_16x16x32_bf16 v[208:211], v[68:71], v[32:35], v[208:211]
    ds_read_b64_tr_b16 v[124:125], v11 offset:24576
    v_mfma_f32_16x16x32_bf16 v[212:215], v[68:71], v[36:39], v[212:215]
    ds_read_b64_tr_b16 v[126:127], v11 offset:25088
    v_mfma_f32_16x16x32_bf16 v[216:219], v[68:71], v[40:43], v[216:219]
    buffer_store_dwordx4 v[4:7], v1, s[68:71], s95 offen offset:1024 sc1
    v_mfma_f32_16x16x32_bf16 v[220:223], v[68:71], v[44:47], v[220:223]
    v_mfma_f32_16x16x32_bf16 v[224:227], v[72:75], v[32:35], v[224:227]
    v_mfma_f32_16x16x32_bf16 v[228:231], v[72:75], v[36:39], v[228:231]
    v_mfma_f32_16x16x32_bf16 v[232:235], v[72:75], v[40:43], v[232:235]
    v_mfma_f32_16x16x32_bf16 v[236:239], v[72:75], v[44:47], v[236:239]
    v_mfma_f32_16x16x32_bf16 v[240:243], v[76:79], v[32:35], v[240:243]
    v_mfma_f32_16x16x32_bf16 v[244:247], v[76:79], v[36:39], v[244:247]
    v_mfma_f32_16x16x32_bf16 v[248:251], v[76:79], v[40:43], v[248:251]
    v_mfma_f32_16x16x32_bf16 v[252:255], v[76:79], v[44:47], v[252:255]
    s_waitcnt lgkmcnt(0)
    v_mfma_f32_16x16x32_bf16 v[128:131], v[96:99], v[80:83], v[128:131]
    v_mfma_f32_16x16x32_bf16 v[132:135], v[96:99], v[84:87], v[132:135]
    s_barrier
    v_mfma_f32_16x16x32_bf16 v[136:139], v[96:99], v[88:91], v[136:139]
    ds_read_b128 v[32:35], v2 offset:0
    v_mfma_f32_16x16x32_bf16 v[140:143], v[96:99], v[92:95], v[140:143]
    ds_read_b64_tr_b16 v[48:49], v8 offset:32768
    v_mfma_f32_16x16x32_bf16 v[144:147], v[100:103], v[80:83], v[144:147]
    ds_read_b64_tr_b16 v[50:51], v8 offset:33280
    v_mfma_f32_16x16x32_bf16 v[148:151], v[100:103], v[84:87], v[148:151]
    ds_read_b64_tr_b16 v[52:53], v8 offset:40960
    v_mfma_f32_16x16x32_bf16 v[152:155], v[100:103], v[88:91], v[152:155]
    ds_read_b64_tr_b16 v[54:55], v8 offset:41472
    v_mfma_f32_16x16x32_bf16 v[156:159], v[100:103], v[92:95], v[156:159]
    ds_read_b128 v[36:39], v2 offset:2048
    v_mfma_f32_16x16x32_bf16 v[160:163], v[104:107], v[80:83], v[160:163]
    ds_read_b64_tr_b16 v[56:57], v9 offset:32768
    v_mfma_f32_16x16x32_bf16 v[164:167], v[104:107], v[84:87], v[164:167]
    ds_read_b64_tr_b16 v[58:59], v9 offset:33280
    v_mfma_f32_16x16x32_bf16 v[168:171], v[104:107], v[88:91], v[168:171]
    ds_read_b64_tr_b16 v[60:61], v9 offset:40960
    v_mfma_f32_16x16x32_bf16 v[172:175], v[104:107], v[92:95], v[172:175]
    ds_read_b64_tr_b16 v[62:63], v9 offset:41472
    v_mfma_f32_16x16x32_bf16 v[176:179], v[108:111], v[80:83], v[176:179]
    ds_read_b128 v[40:43], v2 offset:4096
    v_mfma_f32_16x16x32_bf16 v[180:183], v[108:111], v[84:87], v[180:183]
    ds_read_b64_tr_b16 v[64:65], v10 offset:32768
    v_mfma_f32_16x16x32_bf16 v[184:187], v[108:111], v[88:91], v[184:187]
    ds_read_b64_tr_b16 v[66:67], v10 offset:33280
    v_mfma_f32_16x16x32_bf16 v[188:191], v[108:111], v[92:95], v[188:191]
    ds_read_b64_tr_b16 v[68:69], v10 offset:40960
    v_mfma_f32_16x16x32_bf16 v[192:195], v[112:115], v[80:83], v[192:195]
    ds_read_b64_tr_b16 v[70:71], v10 offset:41472
    v_mfma_f32_16x16x32_bf16 v[196:199], v[112:115], v[84:87], v[196:199]
    ds_read_b128 v[44:47], v2 offset:6144
    v_mfma_f32_16x16x32_bf16 v[200:203], v[112:115], v[88:91], v[200:203]
    ds_read_b64_tr_b16 v[72:73], v11 offset:32768
    v_mfma_f32_16x16x32_bf16 v[204:207], v[112:115], v[92:95], v[204:207]
    ds_read_b64_tr_b16 v[74:75], v11 offset:33280
    v_mfma_f32_16x16x32_bf16 v[208:211], v[116:119], v[80:83], v[208:211]
    ds_read_b64_tr_b16 v[76:77], v11 offset:40960
    v_mfma_f32_16x16x32_bf16 v[212:215], v[116:119], v[84:87], v[212:215]
    ds_read_b64_tr_b16 v[78:79], v11 offset:41472
    v_mfma_f32_16x16x32_bf16 v[216:219], v[116:119], v[88:91], v[216:219]
    v_mfma_f32_16x16x32_bf16 v[220:223], v[116:119], v[92:95], v[220:223]
    v_mfma_f32_16x16x32_bf16 v[224:227], v[120:123], v[80:83], v[224:227]
    v_mfma_f32_16x16x32_bf16 v[228:231], v[120:123], v[84:87], v[228:231]
    v_mfma_f32_16x16x32_bf16 v[232:235], v[120:123], v[88:91], v[232:235]
    v_mfma_f32_16x16x32_bf16 v[236:239], v[120:123], v[92:95], v[236:239]
    v_mfma_f32_16x16x32_bf16 v[240:243], v[124:127], v[80:83], v[240:243]
    v_mfma_f32_16x16x32_bf16 v[244:247], v[124:127], v[84:87], v[244:247]
    v_mfma_f32_16x16x32_bf16 v[248:251], v[124:127], v[88:91], v[248:251]
    v_mfma_f32_16x16x32_bf16 v[252:255], v[124:127], v[92:95], v[252:255]
    s_waitcnt lgkmcnt(0)
    v_mfma_f32_16x16x32_bf16 v[128:131], v[48:51], v[32:35], v[128:131]
    v_mfma_f32_16x16x32_bf16 v[132:135], v[48:51], v[36:39], v[132:135]
    s_barrier
    v_mfma_f32_16x16x32_bf16 v[136:139], v[48:51], v[40:43], v[136:139]
    ds_read_b128 v[80:83], v3 offset:0
    v_mfma_f32_16x16x32_bf16 v[140:143], v[48:51], v[44:47], v[140:143]
    ds_read_b64_tr_b16 v[96:97], v8 offset:49152
    v_mfma_f32_16x16x32_bf16 v[144:147], v[52:55], v[32:35], v[144:147]
    ds_read_b64_tr_b16 v[98:99], v8 offset:49664
    v_mfma_f32_16x16x32_bf16 v[148:151], v[52:55], v[36:39], v[148:151]
    ds_read_b64_tr_b16 v[100:101], v8 offset:57344
    v_mfma_f32_16x16x32_bf16 v[152:155], v[52:55], v[40:43], v[152:155]
    ds_read_b64_tr_b16 v[102:103], v8 offset:57856
    v_mfma_f32_16x16x32_bf16 v[156:159], v[52:55], v[44:47], v[156:159]
    ds_read_b128 v[84:87], v3 offset:2048
    v_mfma_f32_16x16x32_bf16 v[160:163], v[56:59], v[32:35], v[160:163]
    ds_read_b64_tr_b16 v[104:105], v9 offset:49152
    v_mfma_f32_16x16x32_bf16 v[164:167], v[56:59], v[36:39], v[164:167]
    ds_read_b64_tr_b16 v[106:107], v9 offset:49664
    v_mfma_f32_16x16x32_bf16 v[168:171], v[56:59], v[40:43], v[168:171]
    ds_read_b64_tr_b16 v[108:109], v9 offset:57344
    v_mfma_f32_16x16x32_bf16 v[172:175], v[56:59], v[44:47], v[172:175]
    ds_read_b64_tr_b16 v[110:111], v9 offset:57856
    v_mfma_f32_16x16x32_bf16 v[176:179], v[60:63], v[32:35], v[176:179]
    ds_read_b128 v[88:91], v3 offset:4096
    v_mfma_f32_16x16x32_bf16 v[180:183], v[60:63], v[36:39], v[180:183]
    ds_read_b64_tr_b16 v[112:113], v10 offset:49152
    v_mfma_f32_16x16x32_bf16 v[184:187], v[60:63], v[40:43], v[184:187]
    ds_read_b64_tr_b16 v[114:115], v10 offset:49664
    v_mfma_f32_16x16x32_bf16 v[188:191], v[60:63], v[44:47], v[188:191]
    ds_read_b64_tr_b16 v[116:117], v10 offset:57344
    v_mfma_f32_16x16x32_bf16 v[192:195], v[64:67], v[32:35], v[192:195]
    ds_read_b64_tr_b16 v[118:119], v10 offset:57856
    v_mfma_f32_16x16x32_bf16 v[196:199], v[64:67], v[36:39], v[196:199]
    ds_read_b128 v[92:95], v3 offset:6144
    v_mfma_f32_16x16x32_bf16 v[200:203], v[64:67], v[40:43], v[200:203]
    ds_read_b64_tr_b16 v[120:121], v11 offset:49152
    v_mfma_f32_16x16x32_bf16 v[204:207], v[64:67], v[44:47], v[204:207]
    ds_read_b64_tr_b16 v[122:123], v11 offset:49664
    v_mfma_f32_16x16x32_bf16 v[208:211], v[68:71], v[32:35], v[208:211]
    ds_read_b64_tr_b16 v[124:125], v11 offset:57344
    v_mfma_f32_16x16x32_bf16 v[212:215], v[68:71], v[36:39], v[212:215]
    ds_read_b64_tr_b16 v[126:127], v11 offset:57856
    v_mfma_f32_16x16x32_bf16 v[216:219], v[68:71], v[40:43], v[216:219]
    v_mfma_f32_16x16x32_bf16 v[220:223], v[68:71], v[44:47], v[220:223]
    v_mfma_f32_16x16x32_bf16 v[224:227], v[72:75], v[32:35], v[224:227]
    v_mfma_f32_16x16x32_bf16 v[228:231], v[72:75], v[36:39], v[228:231]
    v_mfma_f32_16x16x32_bf16 v[232:235], v[72:75], v[40:43], v[232:235]
    v_mfma_f32_16x16x32_bf16 v[236:239], v[72:75], v[44:47], v[236:239]
    v_mfma_f32_16x16x32_bf16 v[240:243], v[76:79], v[32:35], v[240:243]
    v_mfma_f32_16x16x32_bf16 v[244:247], v[76:79], v[36:39], v[244:247]
    v_mfma_f32_16x16x32_bf16 v[248:251], v[76:79], v[40:43], v[248:251]
    v_mfma_f32_16x16x32_bf16 v[252:255], v[76:79], v[44:47], v[252:255]
    s_waitcnt lgkmcnt(0)
    v_mfma_f32_16x16x32_bf16 v[128:131], v[96:99], v[80:83], v[128:131]
    v_mfma_f32_16x16x32_bf16 v[132:135], v[96:99], v[84:87], v[132:135]
    s_barrier
    v_mfma_f32_16x16x32_bf16 v[136:139], v[96:99], v[88:91], v[136:139]
    ds_read_b128 v[32:35], v2 offset:16384
    v_mfma_f32_16x16x32_bf16 v[140:143], v[96:99], v[92:95], v[140:143]
    ds_read_b64_tr_b16 v[48:49], v8 offset:0
    v_mfma_f32_16x16x32_bf16 v[144:147], v[100:103], v[80:83], v[144:147]
    ds_read_b64_tr_b16 v[50:51], v8 offset:512
    v_mfma_f32_16x16x32_bf16 v[148:151], v[100:103], v[84:87], v[148:151]
    ds_read_b64_tr_b16 v[52:53], v8 offset:8192
    v_mfma_f32_16x16x32_bf16 v[152:155], v[100:103], v[88:91], v[152:155]
    ds_read_b64_tr_b16 v[54:55], v8 offset:8704
    v_mfma_f32_16x16x32_bf16 v[156:159], v[100:103], v[92:95], v[156:159]
    ds_read_b128 v[36:39], v2 offset:18432
    v_mfma_f32_16x16x32_bf16 v[160:163], v[104:107], v[80:83], v[160:163]
    ds_read_b64_tr_b16 v[56:57], v9 offset:0
    v_mfma_f32_16x16x32_bf16 v[164:167], v[104:107], v[84:87], v[164:167]
    ds_read_b64_tr_b16 v[58:59], v9 offset:512
    v_mfma_f32_16x16x32_bf16 v[168:171], v[104:107], v[88:91], v[168:171]
    ds_read_b64_tr_b16 v[60:61], v9 offset:8192
    v_mfma_f32_16x16x32_bf16 v[172:175], v[104:107], v[92:95], v[172:175]
    ds_read_b64_tr_b16 v[62:63], v9 offset:8704
    v_mfma_f32_16x16x32_bf16 v[176:179], v[108:111], v[80:83], v[176:179]
    ds_read_b128 v[40:43], v2 offset:20480
    v_mfma_f32_16x16x32_bf16 v[180:183], v[108:111], v[84:87], v[180:183]
    ds_read_b64_tr_b16 v[64:65], v10 offset:0
    v_mfma_f32_16x16x32_bf16 v[184:187], v[108:111], v[88:91], v[184:187]
    ds_read_b64_tr_b16 v[66:67], v10 offset:512
    v_mfma_f32_16x16x32_bf16 v[188:191], v[108:111], v[92:95], v[188:191]
    ds_read_b64_tr_b16 v[68:69], v10 offset:8192
    v_mfma_f32_16x16x32_bf16 v[192:195], v[112:115], v[80:83], v[192:195]
    ds_read_b64_tr_b16 v[70:71], v10 offset:8704
    v_mfma_f32_16x16x32_bf16 v[196:199], v[112:115], v[84:87], v[196:199]
    ds_read_b128 v[44:47], v2 offset:22528
    v_mfma_f32_16x16x32_bf16 v[200:203], v[112:115], v[88:91], v[200:203]
    ds_read_b64_tr_b16 v[72:73], v11 offset:0
    v_mfma_f32_16x16x32_bf16 v[204:207], v[112:115], v[92:95], v[204:207]
    ds_read_b64_tr_b16 v[74:75], v11 offset:512
    v_mfma_f32_16x16x32_bf16 v[208:211], v[116:119], v[80:83], v[208:211]
    ds_read_b64_tr_b16 v[76:77], v11 offset:8192
    v_mfma_f32_16x16x32_bf16 v[212:215], v[116:119], v[84:87], v[212:215]
    ds_read_b64_tr_b16 v[78:79], v11 offset:8704
    v_mfma_f32_16x16x32_bf16 v[216:219], v[116:119], v[88:91], v[216:219]
    v_mfma_f32_16x16x32_bf16 v[220:223], v[116:119], v[92:95], v[220:223]
    v_mfma_f32_16x16x32_bf16 v[224:227], v[120:123], v[80:83], v[224:227]
    v_mfma_f32_16x16x32_bf16 v[228:231], v[120:123], v[84:87], v[228:231]
    v_mfma_f32_16x16x32_bf16 v[232:235], v[120:123], v[88:91], v[232:235]
    v_mfma_f32_16x16x32_bf16 v[236:239], v[120:123], v[92:95], v[236:239]
    v_mfma_f32_16x16x32_bf16 v[240:243], v[124:127], v[80:83], v[240:243]
    v_mfma_f32_16x16x32_bf16 v[244:247], v[124:127], v[84:87], v[244:247]
    v_mfma_f32_16x16x32_bf16 v[248:251], v[124:127], v[88:91], v[248:251]
    v_mfma_f32_16x16x32_bf16 v[252:255], v[124:127], v[92:95], v[252:255]
    s_waitcnt lgkmcnt(0)
    v_mfma_f32_16x16x32_bf16 v[128:131], v[48:51], v[32:35], v[128:131]
    v_mfma_f32_16x16x32_bf16 v[132:135], v[48:51], v[36:39], v[132:135]
    s_barrier
    v_mfma_f32_16x16x32_bf16 v[136:139], v[48:51], v[40:43], v[136:139]
    ds_read_b128 v[80:83], v3 offset:16384
    v_mfma_f32_16x16x32_bf16 v[140:143], v[48:51], v[44:47], v[140:143]
    ds_read_b64_tr_b16 v[96:97], v8 offset:16384
    v_mfma_f32_16x16x32_bf16 v[144:147], v[52:55], v[32:35], v[144:147]
    ds_read_b64_tr_b16 v[98:99], v8 offset:16896
    v_mfma_f32_16x16x32_bf16 v[148:151], v[52:55], v[36:39], v[148:151]
    ds_read_b64_tr_b16 v[100:101], v8 offset:24576
    v_mfma_f32_16x16x32_bf16 v[152:155], v[52:55], v[40:43], v[152:155]
    ds_read_b64_tr_b16 v[102:103], v8 offset:25088
    v_mfma_f32_16x16x32_bf16 v[156:159], v[52:55], v[44:47], v[156:159]
    ds_read_b128 v[84:87], v3 offset:18432
    v_mfma_f32_16x16x32_bf16 v[160:163], v[56:59], v[32:35], v[160:163]
    ds_read_b64_tr_b16 v[104:105], v9 offset:16384
    v_mfma_f32_16x16x32_bf16 v[164:167], v[56:59], v[36:39], v[164:167]
    ds_read_b64_tr_b16 v[106:107], v9 offset:16896
    v_mfma_f32_16x16x32_bf16 v[168:171], v[56:59], v[40:43], v[168:171]
    ds_read_b64_tr_b16 v[108:109], v9 offset:24576
    v_mfma_f32_16x16x32_bf16 v[172:175], v[56:59], v[44:47], v[172:175]
    ds_read_b64_tr_b16 v[110:111], v9 offset:25088
    v_mfma_f32_16x16x32_bf16 v[176:179], v[60:63], v[32:35], v[176:179]
    ds_read_b128 v[88:91], v3 offset:20480
    v_mfma_f32_16x16x32_bf16 v[180:183], v[60:63], v[36:39], v[180:183]
    ds_read_b64_tr_b16 v[112:113], v10 offset:16384
    v_mfma_f32_16x16x32_bf16 v[184:187], v[60:63], v[40:43], v[184:187]
    ds_read_b64_tr_b16 v[114:115], v10 offset:16896
    v_mfma_f32_16x16x32_bf16 v[188:191], v[60:63], v[44:47], v[188:191]
    ds_read_b64_tr_b16 v[116:117], v10 offset:24576
    v_mfma_f32_16x16x32_bf16 v[192:195], v[64:67], v[32:35], v[192:195]
    ds_read_b64_tr_b16 v[118:119], v10 offset:25088
    v_mfma_f32_16x16x32_bf16 v[196:199], v[64:67], v[36:39], v[196:199]
    ds_read_b128 v[92:95], v3 offset:22528
    v_mfma_f32_16x16x32_bf16 v[200:203], v[64:67], v[40:43], v[200:203]
    ds_read_b64_tr_b16 v[120:121], v11 offset:16384
    v_mfma_f32_16x16x32_bf16 v[204:207], v[64:67], v[44:47], v[204:207]
    ds_read_b64_tr_b16 v[122:123], v11 offset:16896
    v_mfma_f32_16x16x32_bf16 v[208:211], v[68:71], v[32:35], v[208:211]
    ds_read_b64_tr_b16 v[124:125], v11 offset:24576
    v_mfma_f32_16x16x32_bf16 v[212:215], v[68:71], v[36:39], v[212:215]
    ds_read_b64_tr_b16 v[126:127], v11 offset:25088
    v_mfma_f32_16x16x32_bf16 v[216:219], v[68:71], v[40:43], v[216:219]
    s_waitcnt vmcnt(0)
    s_mov_b64 exec, 1
    buffer_store_dword v29, v18, s[68:71], s76 offen sc1
    s_mov_b64 exec, -1
    v_mfma_f32_16x16x32_bf16 v[220:223], v[68:71], v[44:47], v[220:223]
    v_mfma_f32_16x16x32_bf16 v[224:227], v[72:75], v[32:35], v[224:227]
    v_mfma_f32_16x16x32_bf16 v[228:231], v[72:75], v[36:39], v[228:231]
    v_mfma_f32_16x16x32_bf16 v[232:235], v[72:75], v[40:43], v[232:235]
    v_mfma_f32_16x16x32_bf16 v[236:239], v[72:75], v[44:47], v[236:239]
    v_mfma_f32_16x16x32_bf16 v[240:243], v[76:79], v[32:35], v[240:243]
    v_mfma_f32_16x16x32_bf16 v[244:247], v[76:79], v[36:39], v[244:247]
    v_mfma_f32_16x16x32_bf16 v[248:251], v[76:79], v[40:43], v[248:251]
    v_mfma_f32_16x16x32_bf16 v[252:255], v[76:79], v[44:47], v[252:255]
    s_waitcnt lgkmcnt(0)
    v_mfma_f32_16x16x32_bf16 v[128:131], v[96:99], v[80:83], v[128:131]
    v_mfma_f32_16x16x32_bf16 v[132:135], v[96:99], v[84:87], v[132:135]
    s_barrier
    v_mfma_f32_16x16x32_bf16 v[136:139], v[96:99], v[88:91], v[136:139]
    ds_read_b128 v[32:35], v2 offset:32768
    v_mfma_f32_16x16x32_bf16 v[140:143], v[96:99], v[92:95], v[140:143]
    ds_read_b64_tr_b16 v[48:49], v8 offset:32768
    v_mfma_f32_16x16x32_bf16 v[144:147], v[100:103], v[80:83], v[144:147]
    ds_read_b64_tr_b16 v[50:51], v8 offset:33280
    v_mfma_f32_16x16x32_bf16 v[148:151], v[100:103], v[84:87], v[148:151]
    ds_read_b64_tr_b16 v[52:53], v8 offset:40960
    v_mfma_f32_16x16x32_bf16 v[152:155], v[100:103], v[88:91], v[152:155]
    ds_read_b64_tr_b16 v[54:55], v8 offset:41472
    v_mfma_f32_16x16x32_bf16 v[156:159], v[100:103], v[92:95], v[156:159]
    ds_read_b128 v[36:39], v2 offset:34816
    v_mfma_f32_16x16x32_bf16 v[160:163], v[104:107], v[80:83], v[160:163]
    ds_read_b64_tr_b16 v[56:57], v9 offset:32768
    v_mfma_f32_16x16x32_bf16 v[164:167], v[104:107], v[84:87], v[164:167]
    ds_read_b64_tr_b16 v[58:59], v9 offset:33280
    v_mfma_f32_16x16x32_bf16 v[168:171], v[104:107], v[88:91], v[168:171]
    ds_read_b64_tr_b16 v[60:61], v9 offset:40960
    v_mfma_f32_16x16x32_bf16 v[172:175], v[104:107], v[92:95], v[172:175]
    ds_read_b64_tr_b16 v[62:63], v9 offset:41472
    v_mfma_f32_16x16x32_bf16 v[176:179], v[108:111], v[80:83], v[176:179]
    ds_read_b128 v[40:43], v2 offset:36864
    v_mfma_f32_16x16x32_bf16 v[180:183], v[108:111], v[84:87], v[180:183]
    ds_read_b64_tr_b16 v[64:65], v10 offset:32768
    v_mfma_f32_16x16x32_bf16 v[184:187], v[108:111], v[88:91], v[184:187]
    ds_read_b64_tr_b16 v[66:67], v10 offset:33280
    v_mfma_f32_16x16x32_bf16 v[188:191], v[108:111], v[92:95], v[188:191]
    ds_read_b64_tr_b16 v[68:69], v10 offset:40960
    v_mfma_f32_16x16x32_bf16 v[192:195], v[112:115], v[80:83], v[192:195]
    ds_read_b64_tr_b16 v[70:71], v10 offset:41472
    v_mfma_f32_16x16x32_bf16 v[196:199], v[112:115], v[84:87], v[196:199]
    ds_read_b128 v[44:47], v2 offset:38912
    v_mfma_f32_16x16x32_bf16 v[200:203], v[112:115], v[88:91], v[200:203]
    ds_read_b64_tr_b16 v[72:73], v11 offset:32768
    v_mfma_f32_16x16x32_bf16 v[204:207], v[112:115], v[92:95], v[204:207]
    ds_read_b64_tr_b16 v[74:75], v11 offset:33280
    v_mfma_f32_16x16x32_bf16 v[208:211], v[116:119], v[80:83], v[208:211]
    ds_read_b64_tr_b16 v[76:77], v11 offset:40960
    v_mfma_f32_16x16x32_bf16 v[212:215], v[116:119], v[84:87], v[212:215]
    ds_read_b64_tr_b16 v[78:79], v11 offset:41472
    v_mfma_f32_16x16x32_bf16 v[216:219], v[116:119], v[88:91], v[216:219]
    v_mfma_f32_16x16x32_bf16 v[220:223], v[116:119], v[92:95], v[220:223]
    v_mfma_f32_16x16x32_bf16 v[224:227], v[120:123], v[80:83], v[224:227]
    v_mfma_f32_16x16x32_bf16 v[228:231], v[120:123], v[84:87], v[228:231]
    v_mfma_f32_16x16x32_bf16 v[232:235], v[120:123], v[88:91], v[232:235]
    v_mfma_f32_16x16x32_bf16 v[236:239], v[120:123], v[92:95], v[236:239]
    v_mfma_f32_16x16x32_bf16 v[240:243], v[124:127], v[80:83], v[240:243]
    v_mfma_f32_16x16x32_bf16 v[244:247], v[124:127], v[84:87], v[244:247]
    v_mfma_f32_16x16x32_bf16 v[248:251], v[124:127], v[88:91], v[248:251]
    v_mfma_f32_16x16x32_bf16 v[252:255], v[124:127], v[92:95], v[252:255]
    s_waitcnt lgkmcnt(0)
    v_mfma_f32_16x16x32_bf16 v[128:131], v[48:51], v[32:35], v[128:131]
    v_mfma_f32_16x16x32_bf16 v[132:135], v[48:51], v[36:39], v[132:135]
    s_barrier
    v_mfma_f32_16x16x32_bf16 v[136:139], v[48:51], v[40:43], v[136:139]
    ds_read_b128 v[80:83], v3 offset:32768
    v_mfma_f32_16x16x32_bf16 v[140:143], v[48:51], v[44:47], v[140:143]
    ds_read_b64_tr_b16 v[96:97], v8 offset:49152
    v_mfma_f32_16x16x32_bf16 v[144:147], v[52:55], v[32:35], v[144:147]
    ds_read_b64_tr_b16 v[98:99], v8 offset:49664
    v_mfma_f32_16x16x32_bf16 v[148:151], v[52:55], v[36:39], v[148:151]
    ds_read_b64_tr_b16 v[100:101], v8 offset:57344
    v_mfma_f32_16x16x32_bf16 v[152:155], v[52:55], v[40:43], v[152:155]
    ds_read_b64_tr_b16 v[102:103], v8 offset:57856
    v_mfma_f32_16x16x32_bf16 v[156:159], v[52:55], v[44:47], v[156:159]
    ds_read_b128 v[84:87], v3 offset:34816
    v_mfma_f32_16x16x32_bf16 v[160:163], v[56:59], v[32:35], v[160:163]
    ds_read_b64_tr_b16 v[104:105], v9 offset:49152
    v_mfma_f32_16x16x32_bf16 v[164:167], v[56:59], v[36:39], v[164:167]
    ds_read_b64_tr_b16 v[106:107], v9 offset:49664
    v_mfma_f32_16x16x32_bf16 v[168:171], v[56:59], v[40:43], v[168:171]
    ds_read_b64_tr_b16 v[108:109], v9 offset:57344
    v_mfma_f32_16x16x32_bf16 v[172:175], v[56:59], v[44:47], v[172:175]
    ds_read_b64_tr_b16 v[110:111], v9 offset:57856
    v_mfma_f32_16x16x32_bf16 v[176:179], v[60:63], v[32:35], v[176:179]
    ds_read_b128 v[88:91], v3 offset:36864
    v_mfma_f32_16x16x32_bf16 v[180:183], v[60:63], v[36:39], v[180:183]
    ds_read_b64_tr_b16 v[112:113], v10 offset:49152
    v_mfma_f32_16x16x32_bf16 v[184:187], v[60:63], v[40:43], v[184:187]
    ds_read_b64_tr_b16 v[114:115], v10 offset:49664
    v_mfma_f32_16x16x32_bf16 v[188:191], v[60:63], v[44:47], v[188:191]
    ds_read_b64_tr_b16 v[116:117], v10 offset:57344
    v_mfma_f32_16x16x32_bf16 v[192:195], v[64:67], v[32:35], v[192:195]
    ds_read_b64_tr_b16 v[118:119], v10 offset:57856
    v_mfma_f32_16x16x32_bf16 v[196:199], v[64:67], v[36:39], v[196:199]
    ds_read_b128 v[92:95], v3 offset:38912
    v_mfma_f32_16x16x32_bf16 v[200:203], v[64:67], v[40:43], v[200:203]
    ds_read_b64_tr_b16 v[120:121], v11 offset:49152
    v_mfma_f32_16x16x32_bf16 v[204:207], v[64:67], v[44:47], v[204:207]
    ds_read_b64_tr_b16 v[122:123], v11 offset:49664
    v_mfma_f32_16x16x32_bf16 v[208:211], v[68:71], v[32:35], v[208:211]
    ds_read_b64_tr_b16 v[124:125], v11 offset:57344
    v_mfma_f32_16x16x32_bf16 v[212:215], v[68:71], v[36:39], v[212:215]
    ds_read_b64_tr_b16 v[126:127], v11 offset:57856
    v_mfma_f32_16x16x32_bf16 v[216:219], v[68:71], v[40:43], v[216:219]
    v_mfma_f32_16x16x32_bf16 v[220:223], v[68:71], v[44:47], v[220:223]
    v_mfma_f32_16x16x32_bf16 v[224:227], v[72:75], v[32:35], v[224:227]
    v_mfma_f32_16x16x32_bf16 v[228:231], v[72:75], v[36:39], v[228:231]
    v_mfma_f32_16x16x32_bf16 v[232:235], v[72:75], v[40:43], v[232:235]
    v_mfma_f32_16x16x32_bf16 v[236:239], v[72:75], v[44:47], v[236:239]
    v_mfma_f32_16x16x32_bf16 v[240:243], v[76:79], v[32:35], v[240:243]
    v_mfma_f32_16x16x32_bf16 v[244:247], v[76:79], v[36:39], v[244:247]
    v_mfma_f32_16x16x32_bf16 v[248:251], v[76:79], v[40:43], v[248:251]
    v_mfma_f32_16x16x32_bf16 v[252:255], v[76:79], v[44:47], v[252:255]
    s_waitcnt lgkmcnt(0)
    v_mfma_f32_16x16x32_bf16 v[128:131], v[96:99], v[80:83], v[128:131]
    v_mfma_f32_16x16x32_bf16 v[132:135], v[96:99], v[84:87], v[132:135]
    s_barrier
    v_mfma_f32_16x16x32_bf16 v[136:139], v[96:99], v[88:91], v[136:139]
    ds_read_b128 v[32:35], v2 offset:0
    v_mfma_f32_16x16x32_bf16 v[140:143], v[96:99], v[92:95], v[140:143]
    ds_read_b64_tr_b16 v[48:49], v8 offset:0
    v_mfma_f32_16x16x32_bf16 v[144:147], v[100:103], v[80:83], v[144:147]
    ds_read_b64_tr_b16 v[50:51], v8 offset:512
    v_mfma_f32_16x16x32_bf16 v[148:151], v[100:103], v[84:87], v[148:151]
    ds_read_b64_tr_b16 v[52:53], v8 offset:8192
    v_mfma_f32_16x16x32_bf16 v[152:155], v[100:103], v[88:91], v[152:155]
    ds_read_b64_tr_b16 v[54:55], v8 offset:8704
    v_mfma_f32_16x16x32_bf16 v[156:159], v[100:103], v[92:95], v[156:159]
    ds_read_b128 v[36:39], v2 offset:2048
    v_mfma_f32_16x16x32_bf16 v[160:163], v[104:107], v[80:83], v[160:163]
    ds_read_b64_tr_b16 v[56:57], v9 offset:0
    v_mfma_f32_16x16x32_bf16 v[164:167], v[104:107], v[84:87], v[164:167]
    ds_read_b64_tr_b16 v[58:59], v9 offset:512
    v_mfma_f32_16x16x32_bf16 v[168:171], v[104:107], v[88:91], v[168:171]
    ds_read_b64_tr_b16 v[60:61], v9 offset:8192
    v_mfma_f32_16x16x32_bf16 v[172:175], v[104:107], v[92:95], v[172:175]
    ds_read_b64_tr_b16 v[62:63], v9 offset:8704
    v_mfma_f32_16x16x32_bf16 v[176:179], v[108:111], v[80:83], v[176:179]
    ds_read_b128 v[40:43], v2 offset:4096
    v_mfma_f32_16x16x32_bf16 v[180:183], v[108:111], v[84:87], v[180:183]
    ds_read_b64_tr_b16 v[64:65], v10 offset:0
    v_mfma_f32_16x16x32_bf16 v[184:187], v[108:111], v[88:91], v[184:187]
    ds_read_b64_tr_b16 v[66:67], v10 offset:512
    v_mfma_f32_16x16x32_bf16 v[188:191], v[108:111], v[92:95], v[188:191]
    ds_read_b64_tr_b16 v[68:69], v10 offset:8192
    v_mfma_f32_16x16x32_bf16 v[192:195], v[112:115], v[80:83], v[192:195]
    ds_read_b64_tr_b16 v[70:71], v10 offset:8704
    v_mfma_f32_16x16x32_bf16 v[196:199], v[112:115], v[84:87], v[196:199]
    ds_read_b128 v[44:47], v2 offset:6144
    v_mfma_f32_16x16x32_bf16 v[200:203], v[112:115], v[88:91], v[200:203]
    ds_read_b64_tr_b16 v[72:73], v11 offset:0
    v_mfma_f32_16x16x32_bf16 v[204:207], v[112:115], v[92:95], v[204:207]
    ds_read_b64_tr_b16 v[74:75], v11 offset:512
    v_mfma_f32_16x16x32_bf16 v[208:211], v[116:119], v[80:83], v[208:211]
    ds_read_b64_tr_b16 v[76:77], v11 offset:8192
    v_mfma_f32_16x16x32_bf16 v[212:215], v[116:119], v[84:87], v[212:215]
    ds_read_b64_tr_b16 v[78:79], v11 offset:8704
    v_mfma_f32_16x16x32_bf16 v[216:219], v[116:119], v[88:91], v[216:219]
    v_lshlrev_b32 v12, 1, v24
    v_mfma_f32_16x16x32_bf16 v[220:223], v[116:119], v[92:95], v[220:223]
    v_xor_b32 v12, v12, v23
    v_mfma_f32_16x16x32_bf16 v[224:227], v[120:123], v[80:83], v[224:227]
    v_lshlrev_b32 v12, 4, v12
    v_mfma_f32_16x16x32_bf16 v[228:231], v[120:123], v[84:87], v[228:231]
    v_lshl_add_u32 v12, v22, 10, v12
    v_mfma_f32_16x16x32_bf16 v[232:235], v[120:123], v[88:91], v[232:235]
    v_add_u32 v13, 7168, v12
    v_mfma_f32_16x16x32_bf16 v[236:239], v[120:123], v[92:95], v[236:239]
    v_add_u32 v14, 14336, v12
    v_mfma_f32_16x16x32_bf16 v[240:243], v[124:127], v[80:83], v[240:243]
    v_add_u32 v15, 21504, v12
    v_mfma_f32_16x16x32_bf16 v[244:247], v[124:127], v[84:87], v[244:247]
    s_lshl_b32 s13, s96, 8
    s_add_u32 s13, s13, 118784
    v_lshl_add_u32 v22, v27, 2, s13
    v_mfma_f32_16x16x32_bf16 v[248:251], v[124:127], v[88:91], v[248:251]
    v_mfma_f32_16x16x32_bf16 v[252:255], v[124:127], v[92:95], v[252:255]
    s_waitcnt lgkmcnt(0)
    v_mfma_f32_16x16x32_bf16 v[128:131], v[48:51], v[32:35], v[128:131]
    v_mfma_f32_16x16x32_bf16 v[132:135], v[48:51], v[36:39], v[132:135]
    s_barrier
    v_mfma_f32_16x16x32_bf16 v[136:139], v[48:51], v[40:43], v[136:139]
    ds_read_b128 v[80:83], v3 offset:0
    v_mfma_f32_16x16x32_bf16 v[140:143], v[48:51], v[44:47], v[140:143]
    ds_read_b64_tr_b16 v[96:97], v8 offset:16384
    v_mfma_f32_16x16x32_bf16 v[144:147], v[52:55], v[32:35], v[144:147]
    ds_read_b64_tr_b16 v[98:99], v8 offset:16896
    v_mfma_f32_16x16x32_bf16 v[148:151], v[52:55], v[36:39], v[148:151]
    ds_read_b64_tr_b16 v[100:101], v8 offset:24576
    v_mfma_f32_16x16x32_bf16 v[152:155], v[52:55], v[40:43], v[152:155]
    ds_read_b64_tr_b16 v[102:103], v8 offset:25088
    v_mfma_f32_16x16x32_bf16 v[156:159], v[52:55], v[44:47], v[156:159]
    ds_read_b128 v[84:87], v3 offset:2048
    v_mfma_f32_16x16x32_bf16 v[160:163], v[56:59], v[32:35], v[160:163]
    ds_read_b64_tr_b16 v[104:105], v9 offset:16384
    v_mfma_f32_16x16x32_bf16 v[164:167], v[56:59], v[36:39], v[164:167]
    ds_read_b64_tr_b16 v[106:107], v9 offset:16896
    v_mfma_f32_16x16x32_bf16 v[168:171], v[56:59], v[40:43], v[168:171]
    ds_read_b64_tr_b16 v[108:109], v9 offset:24576
    v_mfma_f32_16x16x32_bf16 v[172:175], v[56:59], v[44:47], v[172:175]
    ds_read_b64_tr_b16 v[110:111], v9 offset:25088
    v_mfma_f32_16x16x32_bf16 v[176:179], v[60:63], v[32:35], v[176:179]
    ds_read_b128 v[88:91], v3 offset:4096
    v_mfma_f32_16x16x32_bf16 v[180:183], v[60:63], v[36:39], v[180:183]
    ds_read_b64_tr_b16 v[112:113], v10 offset:16384
    v_mfma_f32_16x16x32_bf16 v[184:187], v[60:63], v[40:43], v[184:187]
    ds_read_b64_tr_b16 v[114:115], v10 offset:16896
    v_mfma_f32_16x16x32_bf16 v[188:191], v[60:63], v[44:47], v[188:191]
    ds_read_b64_tr_b16 v[116:117], v10 offset:24576
    v_mfma_f32_16x16x32_bf16 v[192:195], v[64:67], v[32:35], v[192:195]
    ds_read_b64_tr_b16 v[118:119], v10 offset:25088
    v_mfma_f32_16x16x32_bf16 v[196:199], v[64:67], v[36:39], v[196:199]
    ds_read_b128 v[92:95], v3 offset:6144
    v_mfma_f32_16x16x32_bf16 v[200:203], v[64:67], v[40:43], v[200:203]
    ds_read_b64_tr_b16 v[120:121], v11 offset:16384
    v_mfma_f32_16x16x32_bf16 v[204:207], v[64:67], v[44:47], v[204:207]
    ds_read_b64_tr_b16 v[122:123], v11 offset:16896
    v_mfma_f32_16x16x32_bf16 v[208:211], v[68:71], v[32:35], v[208:211]
    ds_read_b64_tr_b16 v[124:125], v11 offset:24576
    v_mfma_f32_16x16x32_bf16 v[212:215], v[68:71], v[36:39], v[212:215]
    ds_read_b64_tr_b16 v[126:127], v11 offset:25088
    v_mfma_f32_16x16x32_bf16 v[216:219], v[68:71], v[40:43], v[216:219]
    v_mfma_f32_16x16x32_bf16 v[220:223], v[68:71], v[44:47], v[220:223]
    v_mfma_f32_16x16x32_bf16 v[224:227], v[72:75], v[32:35], v[224:227]
    v_mfma_f32_16x16x32_bf16 v[228:231], v[72:75], v[36:39], v[228:231]
    v_mfma_f32_16x16x32_bf16 v[232:235], v[72:75], v[40:43], v[232:235]
    v_mfma_f32_16x16x32_bf16 v[236:239], v[72:75], v[44:47], v[236:239]
    v_mfma_f32_16x16x32_bf16 v[240:243], v[76:79], v[32:35], v[240:243]
    v_mfma_f32_16x16x32_bf16 v[244:247], v[76:79], v[36:39], v[244:247]
    v_mfma_f32_16x16x32_bf16 v[248:251], v[76:79], v[40:43], v[248:251]
    v_mfma_f32_16x16x32_bf16 v[252:255], v[76:79], v[44:47], v[252:255]
    s_waitcnt lgkmcnt(0)
    v_mfma_f32_16x16x32_bf16 v[128:131], v[96:99], v[80:83], v[128:131]
    v_mfma_f32_16x16x32_bf16 v[132:135], v[96:99], v[84:87], v[132:135]
    s_barrier
    v_mfma_f32_16x16x32_bf16 v[136:139], v[96:99], v[88:91], v[136:139]
    ds_read_b128 v[32:35], v2 offset:16384
    v_mfma_f32_16x16x32_bf16 v[140:143], v[96:99], v[92:95], v[140:143]
    ds_read_b64_tr_b16 v[64:65], v8 offset:32768
    v_mfma_f32_16x16x32_bf16 v[144:147], v[100:103], v[80:83], v[144:147]
    ds_read_b128 v[36:39], v2 offset:18432
    v_mfma_f32_16x16x32_bf16 v[148:151], v[100:103], v[84:87], v[148:151]
    ds_read_b64_tr_b16 v[66:67], v8 offset:33280
    v_mfma_f32_16x16x32_bf16 v[152:155], v[100:103], v[88:91], v[152:155]
    ds_read_b128 v[40:43], v2 offset:20480
    v_mfma_f32_16x16x32_bf16 v[156:159], v[100:103], v[92:95], v[156:159]
    ds_read_b64_tr_b16 v[68:69], v8 offset:40960
    v_mfma_f32_16x16x32_bf16 v[160:163], v[104:107], v[80:83], v[160:163]
    ds_read_b128 v[44:47], v2 offset:22528
    v_mfma_f32_16x16x32_bf16 v[164:167], v[104:107], v[84:87], v[164:167]
    ds_read_b64_tr_b16 v[70:71], v8 offset:41472
    v_mfma_f32_16x16x32_bf16 v[168:171], v[104:107], v[88:91], v[168:171]
    ds_read_b128 v[48:51], v3 offset:16384
    v_mfma_f32_16x16x32_bf16 v[172:175], v[104:107], v[92:95], v[172:175]
    ds_read_b64_tr_b16 v[72:73], v8 offset:49152
    v_mfma_f32_16x16x32_bf16 v[176:179], v[108:111], v[80:83], v[176:179]
    ds_read_b128 v[52:55], v3 offset:18432
    v_mfma_f32_16x16x32_bf16 v[180:183], v[108:111], v[84:87], v[180:183]
    ds_read_b64_tr_b16 v[74:75], v8 offset:49664
    v_mfma_f32_16x16x32_bf16 v[184:187], v[108:111], v[88:91], v[184:187]
    ds_read_b128 v[56:59], v3 offset:20480
    v_mfma_f32_16x16x32_bf16 v[188:191], v[108:111], v[92:95], v[188:191]
    ds_read_b64_tr_b16 v[76:77], v8 offset:57344
    v_mfma_f32_16x16x32_bf16 v[192:195], v[112:115], v[80:83], v[192:195]
    ds_read_b128 v[60:63], v3 offset:22528
    v_mfma_f32_16x16x32_bf16 v[196:199], v[112:115], v[84:87], v[196:199]
    ds_read_b64_tr_b16 v[78:79], v8 offset:57856
    v_mfma_f32_16x16x32_bf16 v[200:203], v[112:115], v[88:91], v[200:203]
    s_nop 0
    v_mfma_f32_16x16x32_bf16 v[204:207], v[112:115], v[92:95], v[204:207]
    s_nop 0
    v_mfma_f32_16x16x32_bf16 v[208:211], v[116:119], v[80:83], v[208:211]
    s_nop 0
    v_mfma_f32_16x16x32_bf16 v[212:215], v[116:119], v[84:87], v[212:215]
    s_nop 0
    v_mfma_f32_16x16x32_bf16 v[216:219], v[116:119], v[88:91], v[216:219]
    s_nop 0
    v_mfma_f32_16x16x32_bf16 v[220:223], v[116:119], v[92:95], v[220:223]
    s_nop 0
    v_mfma_f32_16x16x32_bf16 v[224:227], v[120:123], v[80:83], v[224:227]
    s_nop 0
    v_mfma_f32_16x16x32_bf16 v[228:231], v[120:123], v[84:87], v[228:231]
    s_nop 0
    v_mfma_f32_16x16x32_bf16 v[232:235], v[120:123], v[88:91], v[232:235]
    ds_read_b32 v19, v17 offset:16
    v_mfma_f32_16x16x32_bf16 v[236:239], v[120:123], v[92:95], v[236:239]
    v_mfma_f32_16x16x32_bf16 v[240:243], v[124:127], v[80:83], v[240:243]
    v_mfma_f32_16x16x32_bf16 v[244:247], v[124:127], v[84:87], v[244:247]
    v_mfma_f32_16x16x32_bf16 v[248:251], v[124:127], v[88:91], v[248:251]
    v_mfma_f32_16x16x32_bf16 v[252:255], v[124:127], v[92:95], v[252:255]
    s_waitcnt lgkmcnt(0)
    v_cmp_gt_u32 vcc, 1, v19
    s_cbranch_vccnz L_cs1
L_cr2:
    v_mfma_f32_16x16x32_bf16 v[128:131], v[64:67], v[32:35], v[128:131]
    ds_read_b64_tr_b16 v[80:81], v9 offset:32768
    ds_read_b64_tr_b16 v[82:83], v9 offset:33280
    v_mfma_f32_16x16x32_bf16 v[144:147], v[68:71], v[32:35], v[144:147]
    ds_read_b64_tr_b16 v[84:85], v9 offset:40960
    ds_read_b64_tr_b16 v[86:87], v9 offset:41472
    v_mfma_f32_16x16x32_bf16 v[128:131], v[72:75], v[48:51], v[128:131]
    ds_read_b64_tr_b16 v[88:89], v9 offset:49152
    ds_read_b64_tr_b16 v[90:91], v9 offset:49664
    v_mfma_f32_16x16x32_bf16 v[144:147], v[76:79], v[48:51], v[144:147]
    ds_read_b64_tr_b16 v[92:93], v9 offset:57344
    ds_read_b64_tr_b16 v[94:95], v9 offset:57856
    v_mfma_f32_16x16x32_bf16 v[132:135], v[64:67], v[36:39], v[132:135]
    ds_read_b64 v[4:5], v20 offset:0
    ds_read_b64 v[6:7], v21 offset:0
    ds_read_b64 v[28:29], v20 offset:1024
    ds_read_b64 v[30:31], v21 offset:1024
    v_mfma_f32_16x16x32_bf16 v[148:151], v[68:71], v[36:39], v[148:151]
    ds_read_b32 v96, v22 offset:0
    v_mov_b32 v97, 0
    v_mfma_f32_16x16x32_bf16 v[132:135], v[72:75], v[52:55], v[132:135]
    ds_read_b32 v99, v22 offset:0
    v_mov_b32 v98, 0
    v_mfma_f32_16x16x32_bf16 v[148:151], v[76:79], v[52:55], v[148:151]
    ds_read_b32 v100, v22 offset:64
    v_mov_b32 v101, 0
    v_mfma_f32_16x16x32_bf16 v[136:139], v[64:67], v[40:43], v[136:139]
    ds_read_b32 v103, v22 offset:64
    v_mov_b32 v102, 0
    v_mfma_f32_16x16x32_bf16 v[152:155], v[68:71], v[40:43], v[152:155]
    ds_read_b32 v104, v22 offset:128
    v_mov_b32 v105, 0
    v_mfma_f32_16x16x32_bf16 v[136:139], v[72:75], v[56:59], v[136:139]
    ds_read_b32 v107, v22 offset:128
    v_mov_b32 v106, 0
    v_mfma_f32_16x16x32_bf16 v[152:155], v[76:79], v[56:59], v[152:155]
    ds_read_b32 v108, v22 offset:192
    v_mov_b32 v109, 0
    v_mfma_f32_16x16x32_bf16 v[140:143], v[64:67], v[44:47], v[140:143]
    ds_read_b32 v111, v22 offset:192
    v_mov_b32 v110, 0
    v_mfma_f32_16x16x32_bf16 v[156:159], v[68:71], v[44:47], v[156:159]
    v_mfma_f32_16x16x32_bf16 v[140:143], v[72:75], v[60:63], v[140:143]
    v_mfma_f32_16x16x32_bf16 v[156:159], v[76:79], v[60:63], v[156:159]
    s_waitcnt lgkmcnt(0)
    v_mfma_f32_16x16x32_bf16 v[160:163], v[80:83], v[32:35], v[160:163]
    v_mfma_f32_16x16x32_bf16 v[176:179], v[84:87], v[32:35], v[176:179]
    v_mov_b32 v19, 1
    s_mov_b64 exec, 1
    ds_write_b32 v16, v19
    s_mov_b64 exec, -1
    v_mfma_f32_16x16x32_bf16 v[160:163], v[88:91], v[48:51], v[160:163]
    v_mfma_f32_16x16x32_bf16 v[176:179], v[92:95], v[48:51], v[176:179]
    v_mfma_f32_16x16x16_bf16 v[128:131], v[4:5], v[96:97], v[128:131]
    v_mfma_f32_16x16x16_bf16 v[144:147], v[28:29], v[96:97], v[144:147]
    s_nop 2
    v_mfma_f32_16x16x16_bf16 v[160:163], v[4:5], v[98:99], v[160:163]
    v_mfma_f32_16x16x16_bf16 v[176:179], v[28:29], v[98:99], v[176:179]
    v_mfma_f32_16x16x32_bf16 v[164:167], v[80:83], v[36:39], v[164:167]
    v_mfma_f32_16x16x32_bf16 v[180:183], v[84:87], v[36:39], v[180:183]
    s_nop 0
    v_mul_f32 v128, v128, v144
    v_mul_f32 v129, v129, v145
    v_mul_f32 v130, v130, v146
    v_mfma_f32_16x16x32_bf16 v[164:167], v[88:91], v[52:55], v[164:167]
    v_mul_f32 v131, v131, v147
    v_cvt_pk_bf16_f32 v112, v128, v129
    v_cvt_pk_bf16_f32 v113, v130, v131
    v_mfma_f32_16x16x32_bf16 v[180:183], v[92:95], v[52:55], v[180:183]
    v_mul_f32 v160, v160, v176
    v_mul_f32 v161, v161, v177
    v_mul_f32 v162, v162, v178
    v_mfma_f32_16x16x16_bf16 v[132:135], v[4:5], v[100:101], v[132:135]
    v_mul_f32 v163, v163, v179
    v_cvt_pk_bf16_f32 v114, v160, v161
    v_cvt_pk_bf16_f32 v115, v162, v163
    v_mfma_f32_16x16x16_bf16 v[148:151], v[28:29], v[100:101], v[148:151]
    buffer_store_dwordx4 v[112:115], v1, s[72:75], s101 offen offset:0 sc1
    ds_read_b64_tr_b16 v[128:129], v10 offset:32768
    ds_read_b64_tr_b16 v[130:131], v10 offset:33280
    v_mfma_f32_16x16x16_bf16 v[164:167], v[4:5], v[102:103], v[164:167]
    ds_read_b64_tr_b16 v[144:145], v10 offset:40960
    ds_read_b64_tr_b16 v[146:147], v10 offset:41472
    ds_read_b64_tr_b16 v[160:161], v10 offset:49152
    v_mfma_f32_16x16x16_bf16 v[180:183], v[28:29], v[102:103], v[180:183]
    ds_read_b64_tr_b16 v[162:163], v10 offset:49664
    ds_read_b64_tr_b16 v[176:177], v10 offset:57344
    ds_read_b64_tr_b16 v[178:179], v10 offset:57856
    v_mfma_f32_16x16x32_bf16 v[168:171], v[80:83], v[40:43], v[168:171]
    v_mfma_f32_16x16x32_bf16 v[184:187], v[84:87], v[40:43], v[184:187]
    v_mul_f32 v132, v132, v148
    v_mul_f32 v133, v133, v149
    v_mul_f32 v134, v134, v150
    v_mfma_f32_16x16x32_bf16 v[168:171], v[88:91], v[56:59], v[168:171]
    v_mul_f32 v135, v135, v151
    v_cvt_pk_bf16_f32 v116, v132, v133
    v_cvt_pk_bf16_f32 v117, v134, v135
    v_mfma_f32_16x16x32_bf16 v[184:187], v[92:95], v[56:59], v[184:187]
    v_mul_f32 v164, v164, v180
    v_mul_f32 v165, v165, v181
    v_mul_f32 v166, v166, v182
    v_mfma_f32_16x16x16_bf16 v[136:139], v[4:5], v[104:105], v[136:139]
    v_mul_f32 v167, v167, v183
    v_cvt_pk_bf16_f32 v118, v164, v165
    v_cvt_pk_bf16_f32 v119, v166, v167
    v_mfma_f32_16x16x16_bf16 v[152:155], v[28:29], v[104:105], v[152:155]
    buffer_store_dwordx4 v[116:119], v1, s[72:75], s101 offen offset:1024 sc1
    ds_read_b64_tr_b16 v[132:133], v11 offset:32768
    ds_read_b64_tr_b16 v[134:135], v11 offset:33280
    v_mfma_f32_16x16x16_bf16 v[168:171], v[4:5], v[106:107], v[168:171]
    ds_read_b64_tr_b16 v[148:149], v11 offset:40960
    ds_read_b64_tr_b16 v[150:151], v11 offset:41472
    ds_read_b64_tr_b16 v[164:165], v11 offset:49152
    v_mfma_f32_16x16x16_bf16 v[184:187], v[28:29], v[106:107], v[184:187]
    ds_read_b64_tr_b16 v[166:167], v11 offset:49664
    ds_read_b64_tr_b16 v[180:181], v11 offset:57344
    ds_read_b64_tr_b16 v[182:183], v11 offset:57856
    v_mfma_f32_16x16x32_bf16 v[172:175], v[80:83], v[44:47], v[172:175]
    v_mfma_f32_16x16x32_bf16 v[188:191], v[84:87], v[44:47], v[188:191]
    v_mul_f32 v136, v136, v152
    v_mul_f32 v137, v137, v153
    v_mul_f32 v138, v138, v154
    v_mfma_f32_16x16x32_bf16 v[172:175], v[88:91], v[60:63], v[172:175]
    v_mul_f32 v139, v139, v155
    v_cvt_pk_bf16_f32 v120, v136, v137
    v_cvt_pk_bf16_f32 v121, v138, v139
    v_mfma_f32_16x16x32_bf16 v[188:191], v[92:95], v[60:63], v[188:191]
    v_mul_f32 v168, v168, v184
    v_mul_f32 v169, v169, v185
    v_mul_f32 v170, v170, v186
    v_mfma_f32_16x16x16_bf16 v[140:143], v[4:5], v[108:109], v[140:143]
    v_mul_f32 v171, v171, v187
    v_cvt_pk_bf16_f32 v122, v168, v169
    v_cvt_pk_bf16_f32 v123, v170, v171
    v_mfma_f32_16x16x16_bf16 v[156:159], v[28:29], v[108:109], v[156:159]
    buffer_store_dwordx4 v[120:123], v1, s[72:75], s101 offen offset:2048 sc1
    v_mfma_f32_16x16x16_bf16 v[172:175], v[4:5], v[110:111], v[172:175]
    v_mfma_f32_16x16x16_bf16 v[188:191], v[28:29], v[110:111], v[188:191]
    s_waitcnt lgkmcnt(8)
    v_mfma_f32_16x16x32_bf16 v[192:195], v[128:131], v[32:35], v[192:195]
    v_mfma_f32_16x16x32_bf16 v[208:211], v[144:147], v[32:35], v[208:211]
    s_nop 1
    v_mul_f32 v140, v140, v156
    v_mul_f32 v141, v141, v157
    v_mfma_f32_16x16x32_bf16 v[192:195], v[160:163], v[48:51], v[192:195]
    v_mul_f32 v142, v142, v158
    v_mul_f32 v143, v143, v159
    v_mfma_f32_16x16x32_bf16 v[208:211], v[176:179], v[48:51], v[208:211]
    v_cvt_pk_bf16_f32 v124, v140, v141
    v_cvt_pk_bf16_f32 v125, v142, v143
    s_waitcnt lgkmcnt(0)
    v_mfma_f32_16x16x32_bf16 v[224:227], v[132:135], v[32:35], v[224:227]
    v_mul_f32 v172, v172, v188
    v_mul_f32 v173, v173, v189
    v_mfma_f32_16x16x32_bf16 v[240:243], v[148:151], v[32:35], v[240:243]
    v_mul_f32 v174, v174, v190
    v_mul_f32 v175, v175, v191
    v_mfma_f32_16x16x32_bf16 v[224:227], v[164:167], v[48:51], v[224:227]
    v_cvt_pk_bf16_f32 v126, v172, v173
    v_cvt_pk_bf16_f32 v127, v174, v175
    v_mfma_f32_16x16x32_bf16 v[240:243], v[180:183], v[48:51], v[240:243]
    buffer_store_dwordx4 v[124:127], v1, s[72:75], s101 offen offset:3072 sc1
    v_mfma_f32_16x16x16_bf16 v[192:195], v[6:7], v[96:97], v[192:195]
    v_mfma_f32_16x16x16_bf16 v[208:211], v[30:31], v[96:97], v[208:211]
    v_mfma_f32_16x16x16_bf16 v[224:227], v[6:7], v[98:99], v[224:227]
    s_nop 1
    v_mfma_f32_16x16x16_bf16 v[240:243], v[30:31], v[98:99], v[240:243]
    v_mfma_f32_16x16x32_bf16 v[196:199], v[128:131], v[36:39], v[196:199]
    v_mfma_f32_16x16x32_bf16 v[212:215], v[144:147], v[36:39], v[212:215]
    s_nop 1
    v_mul_f32 v192, v192, v208
    v_mul_f32 v193, v193, v209
    v_mfma_f32_16x16x32_bf16 v[196:199], v[160:163], v[52:55], v[196:199]
    v_mul_f32 v194, v194, v210
    v_mul_f32 v195, v195, v211
    v_mfma_f32_16x16x32_bf16 v[212:215], v[176:179], v[52:55], v[212:215]
    v_cvt_pk_bf16_f32 v112, v192, v193
    v_cvt_pk_bf16_f32 v113, v194, v195
    v_mfma_f32_16x16x32_bf16 v[228:231], v[132:135], v[36:39], v[228:231]
    v_mul_f32 v224, v224, v240
    v_mul_f32 v225, v225, v241
    v_mfma_f32_16x16x32_bf16 v[244:247], v[148:151], v[36:39], v[244:247]
    v_mul_f32 v226, v226, v242
    v_mul_f32 v227, v227, v243
    v_mfma_f32_16x16x32_bf16 v[228:231], v[164:167], v[52:55], v[228:231]
    v_cvt_pk_bf16_f32 v114, v224, v225
    v_cvt_pk_bf16_f32 v115, v226, v227
    v_mfma_f32_16x16x32_bf16 v[244:247], v[180:183], v[52:55], v[244:247]
    buffer_store_dwordx4 v[112:115], v1, s[72:75], s93 offen offset:0 sc1
    v_mov_b32 v19, 2
    s_mov_b64 exec, 1
    ds_write_b32 v16, v19
    s_mov_b64 exec, -1
    v_mfma_f32_16x16x16_bf16 v[196:199], v[6:7], v[100:101], v[196:199]
    v_mfma_f32_16x16x16_bf16 v[212:215], v[30:31], v[100:101], v[212:215]
    v_mfma_f32_16x16x16_bf16 v[228:231], v[6:7], v[102:103], v[228:231]
    v_mfma_f32_16x16x16_bf16 v[244:247], v[30:31], v[102:103], v[244:247]
    v_mfma_f32_16x16x32_bf16 v[200:203], v[128:131], v[40:43], v[200:203]
    v_mfma_f32_16x16x32_bf16 v[216:219], v[144:147], v[40:43], v[216:219]
    s_nop 3
    v_mul_f32 v196, v196, v212
    v_mul_f32 v197, v197, v213
    v_mfma_f32_16x16x32_bf16 v[200:203], v[160:163], v[56:59], v[200:203]
    v_mul_f32 v198, v198, v214
    v_mul_f32 v199, v199, v215
    v_mfma_f32_16x16x32_bf16 v[216:219], v[176:179], v[56:59], v[216:219]
    v_cvt_pk_bf16_f32 v116, v196, v197
    v_cvt_pk_bf16_f32 v117, v198, v199
    v_mfma_f32_16x16x32_bf16 v[232:235], v[132:135], v[40:43], v[232:235]
    v_mul_f32 v228, v228, v244
    v_mul_f32 v229, v229, v245
    v_mfma_f32_16x16x32_bf16 v[248:251], v[148:151], v[40:43], v[248:251]
    v_mul_f32 v230, v230, v246
    v_mul_f32 v231, v231, v247
    v_mfma_f32_16x16x32_bf16 v[232:235], v[164:167], v[56:59], v[232:235]
    v_cvt_pk_bf16_f32 v118, v228, v229
    v_cvt_pk_bf16_f32 v119, v230, v231
    v_mfma_f32_16x16x32_bf16 v[248:251], v[180:183], v[56:59], v[248:251]
    buffer_store_dwordx4 v[116:119], v1, s[72:75], s93 offen offset:1024 sc1
    v_mfma_f32_16x16x16_bf16 v[200:203], v[6:7], v[104:105], v[200:203]
    v_mfma_f32_16x16x16_bf16 v[216:219], v[30:31], v[104:105], v[216:219]
    v_mfma_f32_16x16x16_bf16 v[232:235], v[6:7], v[106:107], v[232:235]
    s_nop 1
    v_mfma_f32_16x16x16_bf16 v[248:251], v[30:31], v[106:107], v[248:251]
    v_mfma_f32_16x16x32_bf16 v[204:207], v[128:131], v[44:47], v[204:207]
    v_mfma_f32_16x16x32_bf16 v[220:223], v[144:147], v[44:47], v[220:223]
    s_nop 1
    v_mul_f32 v200, v200, v216
    v_mul_f32 v201, v201, v217
    v_mfma_f32_16x16x32_bf16 v[204:207], v[160:163], v[60:63], v[204:207]
    v_mul_f32 v202, v202, v218
    v_mul_f32 v203, v203, v219
    v_mfma_f32_16x16x32_bf16 v[220:223], v[176:179], v[60:63], v[220:223]
    v_cvt_pk_bf16_f32 v120, v200, v201
    v_cvt_pk_bf16_f32 v121, v202, v203
    v_mfma_f32_16x16x32_bf16 v[236:239], v[132:135], v[44:47], v[236:239]
    v_mul_f32 v232, v232, v248
    v_mul_f32 v233, v233, v249
    v_mfma_f32_16x16x32_bf16 v[252:255], v[148:151], v[44:47], v[252:255]
    v_mul_f32 v234, v234, v250
    v_mul_f32 v235, v235, v251
    v_mfma_f32_16x16x32_bf16 v[236:239], v[164:167], v[60:63], v[236:239]
    v_cvt_pk_bf16_f32 v122, v232, v233
    v_cvt_pk_bf16_f32 v123, v234, v235
    v_mfma_f32_16x16x32_bf16 v[252:255], v[180:183], v[60:63], v[252:255]
    buffer_store_dwordx4 v[120:123], v1, s[72:75], s93 offen offset:2048 sc1
    v_mfma_f32_16x16x16_bf16 v[204:207], v[6:7], v[108:109], v[204:207]
    v_mfma_f32_16x16x16_bf16 v[220:223], v[30:31], v[108:109], v[220:223]
    v_mfma_f32_16x16x16_bf16 v[236:239], v[6:7], v[110:111], v[236:239]
    s_nop 1
    v_mfma_f32_16x16x16_bf16 v[252:255], v[30:31], v[110:111], v[252:255]
    s_nop 3
    v_mul_f32 v204, v204, v220
    v_mul_f32 v205, v205, v221
    v_mul_f32 v206, v206, v222
    v_mul_f32 v207, v207, v223
    v_cvt_pk_bf16_f32 v124, v204, v205
    v_cvt_pk_bf16_f32 v125, v206, v207
    v_mul_f32 v236, v236, v252
    v_mul_f32 v237, v237, v253
    v_mul_f32 v238, v238, v254
    v_mul_f32 v239, v239, v255
    v_cvt_pk_bf16_f32 v126, v236, v237
    v_cvt_pk_bf16_f32 v127, v238, v239
    buffer_store_dwordx4 v[124:127], v1, s[72:75], s93 offen offset:3072 sc1
    v_mov_b32 v19, 3
    s_mov_b64 exec, 1
    ds_write_b32 v16, v19
    s_mov_b64 exec, -1
L_join:
    s_setprio 3
    v_mov_b32 v11, s89
    ds_read_b32 v19, v17
    ds_read_b32 v10, v17 offset:16
    v_lshlrev_b32 v28, 9, v24
    v_lshl_add_u32 v28, v25, 7, v28
    v_lshl_add_u32 v28, v26, 3, v28
    v_bfe_u32 v29, v28, 8, 2
    v_xor_b32 v30, s12, v29
    v_lshl_add_u32 v30, v30, 5, v28
    v_add_u32 v30, 114688, v30
    v_lshlrev_b32 v29, 5, v29
    v_add_u32 v28, s98, v28
    s_waitcnt vmcnt(4)
    s_mov_b64 exec, 1
    buffer_store_dword v11, v18, s[72:75], s100 offen sc1
    s_mov_b64 exec, -1
    v_xor_b32 v2, 0, v29
    v_add_u32 v2, v2, v28
    v_add_u32 v6, 0x10000, v2
    v_xor_b32 v3, 32, v29
    v_add_u32 v3, v3, v28
    v_add_u32 v7, 0x10000, v3
    v_xor_b32 v4, 64, v29
    v_add_u32 v4, v4, v28
    v_add_u32 v8, 0x10000, v4
    v_xor_b32 v5, 96, v29
    v_add_u32 v5, v5, v28
    v_add_u32 v9, 0x10000, v5
    s_waitcnt lgkmcnt(0)
    v_cmp_gt_u32 vcc, 2, v19
    s_cbranch_vccnz L_cs5
L_cr6:
    s_lshl_b32 s13, s99, 16
    s_add_u32 s13, s13, s78
    s_add_u32 m0, s98, 32768
    s_add_u32 s99, s99, 1
    s_cmp_eq_u32 s99, 7
    s_cselect_b32 s99, 0, s99
    buffer_load_dwordx4 v12, s[56:59], s13 offen offset:0 lds
    buffer_load_dwordx4 v13, s[56:59], s13 offen offset:1024 lds
    buffer_load_dwordx4 v14, s[56:59], s13 offen offset:2048 lds
    buffer_load_dwordx4 v15, s[56:59], s13 offen offset:3072 lds
    v_cmp_gt_u32 vcc, 4, v10
    s_cbranch_vccnz L_cs9
L_cr10:
    ds_read_b64_tr_b16 v[128:129], v6 offset:32768
    ds_read_b64_tr_b16 v[130:131], v6 offset:34816
    ds_read_b64_tr_b16 v[132:133], v7 offset:32768
    ds_read_b64_tr_b16 v[134:135], v7 offset:34816
    ds_read_b64_tr_b16 v[136:137], v8 offset:32768
    ds_read_b64_tr_b16 v[138:139], v8 offset:34816
    ds_read_b64_tr_b16 v[140:141], v9 offset:32768
    ds_read_b64_tr_b16 v[142:143], v9 offset:34816
    ds_read_b64_tr_b16 v[144:145], v2 offset:0
    ds_read_b64_tr_b16 v[146:147], v2 offset:2048
    ds_read_b64_tr_b16 v[148:149], v3 offset:0
    ds_read_b64_tr_b16 v[150:151], v3 offset:2048
    ds_read_b64_tr_b16 v[152:153], v4 offset:0
    ds_read_b64_tr_b16 v[154:155], v4 offset:2048
    ds_read_b64_tr_b16 v[156:157], v5 offset:0
    ds_read_b64_tr_b16 v[158:159], v5 offset:2048
    s_lshl_b32 s13, s99, 16
    s_add_u32 s13, s13, s78
    s_add_u32 m0, s98, 49152
    s_add_u32 s99, s99, 1
    s_cmp_eq_u32 s99, 7
    s_cselect_b32 s99, 0, s99
    buffer_load_dwordx4 v12, s[56:59], s13 offen offset:0 lds
    buffer_load_dwordx4 v13, s[56:59], s13 offen offset:1024 lds
    buffer_load_dwordx4 v14, s[56:59], s13 offen offset:2048 lds
    buffer_load_dwordx4 v15, s[56:59], s13 offen offset:3072 lds
    ds_read_b64_tr_b16 v[160:161], v2 offset:16384
    ds_read_b64_tr_b16 v[162:163], v2 offset:18432
    ds_read_b64_tr_b16 v[164:165], v3 offset:16384
    ds_read_b64_tr_b16 v[166:167], v3 offset:18432
    ds_read_b64_tr_b16 v[168:169], v4 offset:16384
    ds_read_b64_tr_b16 v[170:171], v4 offset:18432
    ds_read_b64_tr_b16 v[172:173], v5 offset:16384
    ds_read_b64_tr_b16 v[174:175], v5 offset:18432
    ds_read_b64_tr_b16 v[176:177], v6 offset:0
    ds_read_b64_tr_b16 v[178:179], v6 offset:2048
    ds_read_b64_tr_b16 v[180:181], v7 offset:0
    ds_read_b64_tr_b16 v[182:183], v7 offset:2048
    ds_read_b64_tr_b16 v[184:185], v8 offset:0
    ds_read_b64_tr_b16 v[186:187], v8 offset:2048
    ds_read_b64_tr_b16 v[188:189], v9 offset:0
    ds_read_b64_tr_b16 v[190:191], v9 offset:2048
    v_lshlrev_b32 v31, 3, v24
    v_lshl_add_u32 v31, v27, 10, v31
    s_lshl_b32 s13, s8, 2
    s_add_u32 s13, s13, s12
    s_lshl_b32 s92, s13, 14
    s_lshl_b32 s14, s9, 7
    s_add_u32 s92, s92, s14
    s_lshl_b32 s77, s13, 8
    s_add_u32 s77, s77, 11796488
    v_lshlrev_b32 v27, 4, v27
    v_min_u32 v10, 6, v0
    v_lshlrev_b32 v10, 5, v10
    s_lshl_b32 s13, s12, 10
    v_add_u32 v20, s13, v1
    v_xor_b32 v21, 1024, v20
    v_xor_b32 v22, 2048, v20
    v_xor_b32 v23, 3072, v20
    s_lshl_b32 s94, s8, 5
    s_mul_i32 s14, s12, 7
    s_add_u32 s94, s94, s14
    s_lshl_b32 s94, s94, 5
    s_add_u32 s94, s94, 11862016
    s_mul_i32 s95, s8, 56
    s_mul_i32 s14, s12, 14
    s_add_u32 s95, s95, s14
    s_and_b32 s14, s8, 1
    s_add_u32 s95, s95, s14
    s_lshl_b32 s95, s95, 12
    s_add_u32 s95, s95, 4194304
    ds_read_b64_tr_b16 v[96:97], v6 offset:16384
    ds_read_b64_tr_b16 v[98:99], v6 offset:18432
    ds_read_b64_tr_b16 v[100:101], v7 offset:16384
    ds_read_b64_tr_b16 v[102:103], v7 offset:18432
    ds_read_b64_tr_b16 v[104:105], v8 offset:16384
    ds_read_b64_tr_b16 v[106:107], v8 offset:18432
    ds_read_b64_tr_b16 v[108:109], v9 offset:16384
    ds_read_b64_tr_b16 v[110:111], v9 offset:18432
    s_waitcnt vmcnt(9)
    s_mov_b64 exec, 1
    buffer_store_dword v11, v18, s[72:75], s100 offen offset:4 sc1
    s_mov_b64 exec, -1
    s_waitcnt lgkmcnt(0)
    s_xor_b32 s78, s78, 0x8000
    s_lshl_b32 s13, s99, 16
    s_add_u32 s13, s13, s78
    s_add_u32 m0, s98, 98304
    s_add_u32 s99, s99, 1
    s_cmp_eq_u32 s99, 7
    s_cselect_b32 s99, 0, s99
    buffer_load_dwordx4 v12, s[56:59], s13 offen offset:0 lds
    buffer_load_dwordx4 v13, s[56:59], s13 offen offset:1024 lds
    buffer_load_dwordx4 v14, s[56:59], s13 offen offset:2048 lds
    buffer_load_dwordx4 v15, s[56:59], s13 offen offset:3072 lds
    s_lshl_b32 s13, s99, 16
    s_add_u32 s13, s13, s78
    s_add_u32 m0, s98, 0
    s_add_u32 s99, s99, 1
    s_cmp_eq_u32 s99, 7
    s_cselect_b32 s99, 0, s99
    buffer_load_dwordx4 v12, s[56:59], s13 offen offset:0 lds
    buffer_load_dwordx4 v13, s[56:59], s13 offen offset:1024 lds
    buffer_load_dwordx4 v14, s[56:59], s13 offen offset:2048 lds
    buffer_load_dwordx4 v15, s[56:59], s13 offen offset:3072 lds
    s_lshl_b32 s13, s99, 16
    s_add_u32 s13, s13, s78
    s_add_u32 m0, s98, 16384
    s_add_u32 s99, s99, 1
    s_cmp_eq_u32 s99, 7
    s_cselect_b32 s99, 0, s99
    buffer_load_dwordx4 v12, s[56:59], s13 offen offset:0 lds
    buffer_load_dwordx4 v13, s[56:59], s13 offen offset:1024 lds
    buffer_load_dwordx4 v14, s[56:59], s13 offen offset:2048 lds
    buffer_load_dwordx4 v15, s[56:59], s13 offen offset:3072 lds
    buffer_load_dword v11, v10, s[68:71], s94 offen offset:0 sc1
    s_lshl_b32 s13, s99, 16
    s_add_u32 s13, s13, s78
    s_add_u32 m0, s98, 65536
    s_add_u32 s99, s99, 1
    s_cmp_eq_u32 s99, 7
    s_cselect_b32 s99, 0, s99
    buffer_load_dwordx4 v12, s[56:59], s13 offen offset:0 lds
    buffer_load_dwordx4 v13, s[56:59], s13 offen offset:1024 lds
    buffer_load_dwordx4 v14, s[56:59], s13 offen offset:2048 lds
    buffer_load_dwordx4 v15, s[56:59], s13 offen offset:3072 lds
    s_lshl_b32 s13, s99, 16
    s_add_u32 s13, s13, s78
    s_add_u32 m0, s98, 81920
    s_add_u32 s99, s99, 1
    s_cmp_eq_u32 s99, 7
    s_cselect_b32 s99, 0, s99
    buffer_load_dwordx4 v12, s[56:59], s13 offen offset:0 lds
    buffer_load_dwordx4 v13, s[56:59], s13 offen offset:1024 lds
    buffer_load_dwordx4 v14, s[56:59], s13 offen offset:2048 lds
    buffer_load_dwordx4 v15, s[56:59], s13 offen offset:3072 lds
    buffer_load_dwordx2 v[28:29], v27, s[68:71], s77 offen sc1
    s_waitcnt vmcnt(9)
    v_cmp_ne_u32 vcc, s89, v11
    s_cbranch_vccnz L_hs13
L_hr14:
    s_lshl_b32 s15, s79, 13
    s_add_u32 s15, s15, s95
    s_add_u32 s79, s79, 1
    s_cmp_eq_u32 s79, 7
    s_cselect_b32 s79, 0, s79
    buffer_load_dwordx4 v[32:35], v20, s[68:71], s15 offen sc1
    buffer_load_dwordx4 v[36:39], v21, s[68:71], s15 offen sc1
    buffer_load_dwordx4 v[40:43], v22, s[68:71], s15 offen sc1
    buffer_load_dwordx4 v[44:47], v23, s[68:71], s15 offen sc1
    s_lshl_b32 s15, s79, 13
    s_add_u32 s15, s15, s95
    s_add_u32 s79, s79, 1
    s_cmp_eq_u32 s79, 7
    s_cselect_b32 s79, 0, s79
    buffer_load_dwordx4 v[48:51], v20, s[68:71], s15 offen sc1
    buffer_load_dwordx4 v[52:55], v21, s[68:71], s15 offen sc1
    buffer_load_dwordx4 v[56:59], v22, s[68:71], s15 offen sc1
    buffer_load_dwordx4 v[60:63], v23, s[68:71], s15 offen sc1
    s_lshl_b32 s15, s79, 13
    s_add_u32 s15, s15, s95
    s_add_u32 s79, s79, 1
    s_cmp_eq_u32 s79, 7
    s_cselect_b32 s79, 0, s79
    buffer_load_dwordx4 v[64:67], v20, s[68:71], s15 offen sc1
    buffer_load_dwordx4 v[68:71], v21, s[68:71], s15 offen sc1
    buffer_load_dwordx4 v[72:75], v22, s[68:71], s15 offen sc1
    buffer_load_dwordx4 v[76:79], v23, s[68:71], s15 offen sc1
    s_lshl_b32 s15, s79, 13
    s_add_u32 s15, s15, s95
    s_add_u32 s79, s79, 1
    s_cmp_eq_u32 s79, 7
    s_cselect_b32 s79, 0, s79
    buffer_load_dwordx4 v[80:83], v20, s[68:71], s15 offen sc1
    buffer_load_dwordx4 v[84:87], v21, s[68:71], s15 offen sc1
    buffer_load_dwordx4 v[88:91], v22, s[68:71], s15 offen sc1
    buffer_load_dwordx4 v[92:95], v23, s[68:71], s15 offen sc1
    s_lshl_b32 s15, s79, 13
    s_add_u32 s15, s15, s95
    s_add_u32 s79, s79, 1
    s_cmp_eq_u32 s79, 7
    s_cselect_b32 s79, 0, s79
    buffer_load_dwordx4 v[112:115], v20, s[68:71], s15 offen sc1
    buffer_load_dwordx4 v[116:119], v21, s[68:71], s15 offen sc1
    buffer_load_dwordx4 v[120:123], v22, s[68:71], s15 offen sc1
    buffer_load_dwordx4 v[124:127], v23, s[68:71], s15 offen sc1
    s_setprio 1
    buffer_load_dword v11, v10, s[68:71], s94 offen offset:4 sc1
    s_waitcnt vmcnt(20)
    v_mfma_f32_16x16x32_bf16 v[192:195], v[128:131], v[32:35], 0
    v_mfma_f32_16x16x32_bf16 v[196:199], v[132:135], v[32:35], 0
    v_mfma_f32_16x16x32_bf16 v[200:203], v[136:139], v[32:35], 0
    v_mfma_f32_16x16x32_bf16 v[204:207], v[140:143], v[32:35], 0
    s_lshl_b32 s15, s79, 13
    s_add_u32 s15, s15, s95
    s_add_u32 s79, s79, 1
    s_cmp_eq_u32 s79, 7
    s_cselect_b32 s79, 0, s79
    buffer_load_dwordx4 v[32:35], v20, s[68:71], s15 offen sc1
    s_waitcnt vmcnt(20)
    v_mfma_f32_16x16x32_bf16 v[208:211], v[128:131], v[36:39], 0
    v_mfma_f32_16x16x32_bf16 v[212:215], v[132:135], v[36:39], 0
    v_mfma_f32_16x16x32_bf16 v[216:219], v[136:139], v[36:39], 0
    v_mfma_f32_16x16x32_bf16 v[220:223], v[140:143], v[36:39], 0
    buffer_load_dwordx4 v[36:39], v21, s[68:71], s15 offen sc1
    s_waitcnt vmcnt(20)
    v_mfma_f32_16x16x32_bf16 v[224:227], v[128:131], v[40:43], 0
    v_mfma_f32_16x16x32_bf16 v[228:231], v[132:135], v[40:43], 0
    v_mfma_f32_16x16x32_bf16 v[232:235], v[136:139], v[40:43], 0
    v_mfma_f32_16x16x32_bf16 v[236:239], v[140:143], v[40:43], 0
    buffer_load_dwordx4 v[40:43], v22, s[68:71], s15 offen sc1
    s_waitcnt vmcnt(20)
    v_mfma_f32_16x16x32_bf16 v[240:243], v[128:131], v[44:47], 0
    v_mfma_f32_16x16x32_bf16 v[244:247], v[132:135], v[44:47], 0
    v_mfma_f32_16x16x32_bf16 v[248:251], v[136:139], v[44:47], 0
    v_mfma_f32_16x16x32_bf16 v[252:255], v[140:143], v[44:47], 0
    buffer_load_dwordx4 v[44:47], v23, s[68:71], s15 offen sc1
    s_waitcnt vmcnt(20)
    v_mfma_f32_16x16x32_bf16 v[192:195], v[144:147], v[48:51], v[192:195]
    s_waitcnt vmcnt(52)
    v_mfma_f32_16x16x32_bf16 v[196:199], v[148:151], v[48:51], v[196:199]
    ds_read_b64_tr_b16 v[128:129], v2 offset:32768
    v_mfma_f32_16x16x32_bf16 v[200:203], v[152:155], v[48:51], v[200:203]
    ds_read_b64_tr_b16 v[130:131], v2 offset:34816
    v_mfma_f32_16x16x32_bf16 v[204:207], v[156:159], v[48:51], v[204:207]
    s_lshl_b32 s15, s79, 13
    s_add_u32 s15, s15, s95
    s_add_u32 s79, s79, 1
    s_cmp_eq_u32 s79, 7
    s_cselect_b32 s79, 0, s79
    buffer_load_dwordx4 v[48:51], v20, s[68:71], s15 offen sc1
    s_waitcnt vmcnt(20)
    v_mfma_f32_16x16x32_bf16 v[208:211], v[144:147], v[52:55], v[208:211]
    ds_read_b64_tr_b16 v[132:133], v3 offset:32768
    v_mfma_f32_16x16x32_bf16 v[212:215], v[148:151], v[52:55], v[212:215]
    ds_read_b64_tr_b16 v[134:135], v3 offset:34816
    v_mfma_f32_16x16x32_bf16 v[216:219], v[152:155], v[52:55], v[216:219]
    ds_read_b64_tr_b16 v[136:137], v4 offset:32768
    v_mfma_f32_16x16x32_bf16 v[220:223], v[156:159], v[52:55], v[220:223]
    buffer_load_dwordx4 v[52:55], v21, s[68:71], s15 offen sc1
    s_waitcnt vmcnt(20)
    v_mfma_f32_16x16x32_bf16 v[224:227], v[144:147], v[56:59], v[224:227]
    ds_read_b64_tr_b16 v[138:139], v4 offset:34816
    v_mfma_f32_16x16x32_bf16 v[228:231], v[148:151], v[56:59], v[228:231]
    ds_read_b64_tr_b16 v[140:141], v5 offset:32768
    v_mfma_f32_16x16x32_bf16 v[232:235], v[152:155], v[56:59], v[232:235]
    ds_read_b64_tr_b16 v[142:143], v5 offset:34816
    v_mfma_f32_16x16x32_bf16 v[236:239], v[156:159], v[56:59], v[236:239]
    buffer_load_dwordx4 v[56:59], v22, s[68:71], s15 offen sc1
    s_waitcnt vmcnt(20)
    v_mfma_f32_16x16x32_bf16 v[240:243], v[144:147], v[60:63], v[240:243]
    v_mfma_f32_16x16x32_bf16 v[244:247], v[148:151], v[60:63], v[244:247]
    v_mfma_f32_16x16x32_bf16 v[248:251], v[152:155], v[60:63], v[248:251]
    v_mfma_f32_16x16x32_bf16 v[252:255], v[156:159], v[60:63], v[252:255]
    buffer_load_dwordx4 v[60:63], v23, s[68:71], s15 offen sc1
    s_waitcnt vmcnt(20)
    v_mfma_f32_16x16x32_bf16 v[192:195], v[160:163], v[64:67], v[192:195]
    s_waitcnt lgkmcnt(0)
    s_lshl_b32 s13, s99, 16
    s_add_u32 s13, s13, s78
    s_add_u32 m0, s98, 32768
    s_add_u32 s99, s99, 1
    s_cmp_eq_u32 s99, 7
    s_cselect_b32 s99, 0, s99
    v_mfma_f32_16x16x32_bf16 v[196:199], v[164:167], v[64:67], v[196:199]
    buffer_load_dwordx4 v12, s[56:59], s13 offen offset:0 lds
    buffer_load_dwordx4 v13, s[56:59], s13 offen offset:1024 lds
    v_mfma_f32_16x16x32_bf16 v[200:203], v[168:171], v[64:67], v[200:203]
    buffer_load_dwordx4 v14, s[56:59], s13 offen offset:2048 lds
    buffer_load_dwordx4 v15, s[56:59], s13 offen offset:3072 lds
    v_mfma_f32_16x16x32_bf16 v[204:207], v[172:175], v[64:67], v[204:207]
    s_waitcnt vmcnt(12)
    v_cmp_ne_u32 vcc, s89, v11
    s_cbranch_vccnz L_hs16
L_hr17:
    s_xor_b32 s95, s95, 4096
    s_lshl_b32 s15, s79, 13
    s_add_u32 s15, s15, s95
    s_add_u32 s79, s79, 1
    s_cmp_eq_u32 s79, 7
    s_cselect_b32 s79, 0, s79
    buffer_load_dwordx4 v[64:67], v20, s[68:71], s15 offen sc1
    s_waitcnt vmcnt(24)
    v_mfma_f32_16x16x32_bf16 v[208:211], v[160:163], v[68:71], v[208:211]
    s_waitcnt vmcnt(57)
    ds_read_b64_tr_b16 v[144:145], v2 offset:49152
    v_mfma_f32_16x16x32_bf16 v[212:215], v[164:167], v[68:71], v[212:215]
    ds_read_b64_tr_b16 v[146:147], v2 offset:51200
    ds_read_b64_tr_b16 v[148:149], v3 offset:49152
    v_mfma_f32_16x16x32_bf16 v[216:219], v[168:171], v[68:71], v[216:219]
    ds_read_b64_tr_b16 v[150:151], v3 offset:51200
    ds_read_b64_tr_b16 v[152:153], v4 offset:49152
    v_mfma_f32_16x16x32_bf16 v[220:223], v[172:175], v[68:71], v[220:223]
    buffer_load_dwordx4 v[68:71], v21, s[68:71], s15 offen sc1
    s_waitcnt vmcnt(24)
    v_mfma_f32_16x16x32_bf16 v[224:227], v[160:163], v[72:75], v[224:227]
    ds_read_b64_tr_b16 v[154:155], v4 offset:51200
    ds_read_b64_tr_b16 v[156:157], v5 offset:49152
    v_mfma_f32_16x16x32_bf16 v[228:231], v[164:167], v[72:75], v[228:231]
    ds_read_b64_tr_b16 v[158:159], v5 offset:51200
    v_mfma_f32_16x16x32_bf16 v[232:235], v[168:171], v[72:75], v[232:235]
    v_mfma_f32_16x16x32_bf16 v[236:239], v[172:175], v[72:75], v[236:239]
    buffer_load_dwordx4 v[72:75], v22, s[68:71], s15 offen sc1
    s_waitcnt vmcnt(24)
    v_mfma_f32_16x16x32_bf16 v[240:243], v[160:163], v[76:79], v[240:243]
    v_mfma_f32_16x16x32_bf16 v[244:247], v[164:167], v[76:79], v[244:247]
    v_mfma_f32_16x16x32_bf16 v[248:251], v[168:171], v[76:79], v[248:251]
    v_mfma_f32_16x16x32_bf16 v[252:255], v[172:175], v[76:79], v[252:255]
    buffer_load_dwordx4 v[76:79], v23, s[68:71], s15 offen sc1
    s_waitcnt vmcnt(24)
    v_mfma_f32_16x16x32_bf16 v[192:195], v[176:179], v[80:83], v[192:195]
    s_waitcnt lgkmcnt(0)
    s_lshl_b32 s13, s99, 16
    s_add_u32 s13, s13, s78
    s_add_u32 m0, s98, 49152
    s_add_u32 s99, s99, 1
    s_cmp_eq_u32 s99, 7
    s_cselect_b32 s99, 0, s99
    v_mfma_f32_16x16x32_bf16 v[196:199], v[180:183], v[80:83], v[196:199]
    buffer_load_dwordx4 v12, s[56:59], s13 offen offset:0 lds
    buffer_load_dwordx4 v13, s[56:59], s13 offen offset:1024 lds
    v_mfma_f32_16x16x32_bf16 v[200:203], v[184:187], v[80:83], v[200:203]
    buffer_load_dwordx4 v14, s[56:59], s13 offen offset:2048 lds
    buffer_load_dwordx4 v15, s[56:59], s13 offen offset:3072 lds
    v_mfma_f32_16x16x32_bf16 v[204:207], v[188:191], v[80:83], v[204:207]
    s_lshl_b32 s15, s79, 13
    s_add_u32 s15, s15, s95
    s_add_u32 s79, s79, 1
    s_cmp_eq_u32 s79, 7
    s_cselect_b32 s79, 0, s79
    buffer_load_dwordx4 v[80:83], v20, s[68:71], s15 offen sc1
    s_waitcnt vmcnt(28)
    v_mfma_f32_16x16x32_bf16 v[208:211], v[176:179], v[84:87], v[208:211]
    s_waitcnt vmcnt(60)
    ds_read_b64_tr_b16 v[160:161], v6 offset:32768
    v_mfma_f32_16x16x32_bf16 v[212:215], v[180:183], v[84:87], v[212:215]
    ds_read_b64_tr_b16 v[162:163], v6 offset:34816
    ds_read_b64_tr_b16 v[164:165], v7 offset:32768
    v_mfma_f32_16x16x32_bf16 v[216:219], v[184:187], v[84:87], v[216:219]
    ds_read_b64_tr_b16 v[166:167], v7 offset:34816
    ds_read_b64_tr_b16 v[168:169], v8 offset:32768
    v_mfma_f32_16x16x32_bf16 v[220:223], v[188:191], v[84:87], v[220:223]
    buffer_load_dwordx4 v[84:87], v21, s[68:71], s15 offen sc1
    s_waitcnt vmcnt(28)
    v_mfma_f32_16x16x32_bf16 v[224:227], v[176:179], v[88:91], v[224:227]
    ds_read_b64_tr_b16 v[170:171], v8 offset:34816
    ds_read_b64_tr_b16 v[172:173], v9 offset:32768
    v_mfma_f32_16x16x32_bf16 v[228:231], v[180:183], v[88:91], v[228:231]
    ds_read_b64_tr_b16 v[174:175], v9 offset:34816
    v_mfma_f32_16x16x32_bf16 v[232:235], v[184:187], v[88:91], v[232:235]
    v_mfma_f32_16x16x32_bf16 v[236:239], v[188:191], v[88:91], v[236:239]
    buffer_load_dwordx4 v[88:91], v22, s[68:71], s15 offen sc1
    s_waitcnt vmcnt(28)
    v_mfma_f32_16x16x32_bf16 v[240:243], v[176:179], v[92:95], v[240:243]
    v_mfma_f32_16x16x32_bf16 v[244:247], v[180:183], v[92:95], v[244:247]
    v_mfma_f32_16x16x32_bf16 v[248:251], v[184:187], v[92:95], v[248:251]
    v_mfma_f32_16x16x32_bf16 v[252:255], v[188:191], v[92:95], v[252:255]
    buffer_load_dwordx4 v[92:95], v23, s[68:71], s15 offen sc1
    s_waitcnt vmcnt(28)
    v_mfma_f32_16x16x32_bf16 v[192:195], v[96:99], v[112:115], v[192:195]
    s_waitcnt vmcnt(59)
    v_mfma_f32_16x16x32_bf16 v[196:199], v[100:103], v[112:115], v[196:199]
    ds_read_b64_tr_b16 v[176:177], v2 offset:0
    v_mfma_f32_16x16x32_bf16 v[200:203], v[104:107], v[112:115], v[200:203]
    ds_read_b64_tr_b16 v[178:179], v2 offset:2048
    v_mfma_f32_16x16x32_bf16 v[204:207], v[108:111], v[112:115], v[204:207]
    s_lshl_b32 s15, s79, 13
    s_add_u32 s15, s15, s95
    s_add_u32 s79, s79, 1
    s_cmp_eq_u32 s79, 7
    s_cselect_b32 s79, 0, s79
    buffer_load_dwordx4 v[112:115], v20, s[68:71], s15 offen sc1
    s_waitcnt vmcnt(28)
    v_mfma_f32_16x16x32_bf16 v[208:211], v[96:99], v[116:119], v[208:211]
    ds_read_b64_tr_b16 v[180:181], v3 offset:0
    v_mfma_f32_16x16x32_bf16 v[212:215], v[100:103], v[116:119], v[212:215]
    ds_read_b64_tr_b16 v[182:183], v3 offset:2048
    v_mfma_f32_16x16x32_bf16 v[216:219], v[104:107], v[116:119], v[216:219]
    ds_read_b64_tr_b16 v[184:185], v4 offset:0
    v_mfma_f32_16x16x32_bf16 v[220:223], v[108:111], v[116:119], v[220:223]
    buffer_load_dwordx4 v[116:119], v21, s[68:71], s15 offen sc1
    s_waitcnt vmcnt(28)
    v_mfma_f32_16x16x32_bf16 v[224:227], v[96:99], v[120:123], v[224:227]
    ds_read_b64_tr_b16 v[186:187], v4 offset:2048
    v_mfma_f32_16x16x32_bf16 v[228:231], v[100:103], v[120:123], v[228:231]
    ds_read_b64_tr_b16 v[188:189], v5 offset:0
    v_mfma_f32_16x16x32_bf16 v[232:235], v[104:107], v[120:123], v[232:235]
    ds_read_b64_tr_b16 v[190:191], v5 offset:2048
    v_mfma_f32_16x16x32_bf16 v[236:239], v[108:111], v[120:123], v[236:239]
    buffer_load_dwordx4 v[120:123], v22, s[68:71], s15 offen sc1
    s_waitcnt vmcnt(28)
    v_mfma_f32_16x16x32_bf16 v[240:243], v[96:99], v[124:127], v[240:243]
    v_mfma_f32_16x16x32_bf16 v[244:247], v[100:103], v[124:127], v[244:247]
    v_mfma_f32_16x16x32_bf16 v[248:251], v[104:107], v[124:127], v[248:251]
    v_mfma_f32_16x16x32_bf16 v[252:255], v[108:111], v[124:127], v[252:255]
    buffer_load_dwordx4 v[124:127], v23, s[68:71], s15 offen sc1
    s_waitcnt lgkmcnt(15)
    s_waitcnt vmcnt(27)
    v_mfma_f32_16x16x32_bf16 v[192:195], v[128:131], v[32:35], v[192:195]
    s_waitcnt vmcnt(59)
    v_mfma_f32_16x16x32_bf16 v[196:199], v[132:135], v[32:35], v[196:199]
    ds_read_b64_tr_b16 v[96:97], v2 offset:16384
    v_mfma_f32_16x16x32_bf16 v[200:203], v[136:139], v[32:35], v[200:203]
    ds_read_b64_tr_b16 v[98:99], v2 offset:18432
    v_mfma_f32_16x16x32_bf16 v[204:207], v[140:143], v[32:35], v[204:207]
    s_lshl_b32 s15, s79, 13
    s_add_u32 s15, s15, s95
    s_add_u32 s79, s79, 1
    s_cmp_eq_u32 s79, 7
    s_cselect_b32 s79, 0, s79
    buffer_load_dwordx4 v[32:35], v20, s[68:71], s15 offen sc1
    s_waitcnt vmcnt(27)
    v_mfma_f32_16x16x32_bf16 v[208:211], v[128:131], v[36:39], v[208:211]
    ds_read_b64_tr_b16 v[100:101], v3 offset:16384
    v_mfma_f32_16x16x32_bf16 v[212:215], v[132:135], v[36:39], v[212:215]
    ds_read_b64_tr_b16 v[102:103], v3 offset:18432
    v_mfma_f32_16x16x32_bf16 v[216:219], v[136:139], v[36:39], v[216:219]
    ds_read_b64_tr_b16 v[104:105], v4 offset:16384
    v_mfma_f32_16x16x32_bf16 v[220:223], v[140:143], v[36:39], v[220:223]
    buffer_load_dwordx4 v[36:39], v21, s[68:71], s15 offen sc1
    s_waitcnt vmcnt(27)
    v_mfma_f32_16x16x32_bf16 v[224:227], v[128:131], v[40:43], v[224:227]
    ds_read_b64_tr_b16 v[106:107], v4 offset:18432
    v_mfma_f32_16x16x32_bf16 v[228:231], v[132:135], v[40:43], v[228:231]
    ds_read_b64_tr_b16 v[108:109], v5 offset:16384
    v_mfma_f32_16x16x32_bf16 v[232:235], v[136:139], v[40:43], v[232:235]
    ds_read_b64_tr_b16 v[110:111], v5 offset:18432
    v_mfma_f32_16x16x32_bf16 v[236:239], v[140:143], v[40:43], v[236:239]
    buffer_load_dwordx4 v[40:43], v22, s[68:71], s15 offen sc1
    s_waitcnt vmcnt(27)
    v_mfma_f32_16x16x32_bf16 v[240:243], v[128:131], v[44:47], v[240:243]
    v_mfma_f32_16x16x32_bf16 v[244:247], v[132:135], v[44:47], v[244:247]
    v_mfma_f32_16x16x32_bf16 v[248:251], v[136:139], v[44:47], v[248:251]
    v_mfma_f32_16x16x32_bf16 v[252:255], v[140:143], v[44:47], v[252:255]
    buffer_load_dwordx4 v[44:47], v23, s[68:71], s15 offen sc1
    s_waitcnt lgkmcnt(15)
    s_waitcnt vmcnt(27)
    v_mfma_f32_16x16x32_bf16 v[192:195], v[144:147], v[48:51], v[192:195]
    s_waitcnt vmcnt(58)
    v_mfma_f32_16x16x32_bf16 v[196:199], v[148:151], v[48:51], v[196:199]
    ds_read_b64_tr_b16 v[128:129], v6 offset:0
    v_mfma_f32_16x16x32_bf16 v[200:203], v[152:155], v[48:51], v[200:203]
    ds_read_b64_tr_b16 v[130:131], v6 offset:2048
    v_mfma_f32_16x16x32_bf16 v[204:207], v[156:159], v[48:51], v[204:207]
    s_lshl_b32 s15, s79, 13
    s_add_u32 s15, s15, s95
    s_add_u32 s79, s79, 1
    s_cmp_eq_u32 s79, 7
    s_cselect_b32 s79, 0, s79
    buffer_load_dwordx4 v[48:51], v20, s[68:71], s15 offen sc1
    s_waitcnt vmcnt(27)
    v_mfma_f32_16x16x32_bf16 v[208:211], v[144:147], v[52:55], v[208:211]
    ds_read_b64_tr_b16 v[132:133], v7 offset:0
    v_mfma_f32_16x16x32_bf16 v[212:215], v[148:151], v[52:55], v[212:215]
    ds_read_b64_tr_b16 v[134:135], v7 offset:2048
    v_mfma_f32_16x16x32_bf16 v[216:219], v[152:155], v[52:55], v[216:219]
    ds_read_b64_tr_b16 v[136:137], v8 offset:0
    v_mfma_f32_16x16x32_bf16 v[220:223], v[156:159], v[52:55], v[220:223]
    buffer_load_dwordx4 v[52:55], v21, s[68:71], s15 offen sc1
    s_waitcnt vmcnt(27)
    v_mfma_f32_16x16x32_bf16 v[224:227], v[144:147], v[56:59], v[224:227]
    ds_read_b64_tr_b16 v[138:139], v8 offset:2048
    v_mfma_f32_16x16x32_bf16 v[228:231], v[148:151], v[56:59], v[228:231]
    ds_read_b64_tr_b16 v[140:141], v9 offset:0
    v_mfma_f32_16x16x32_bf16 v[232:235], v[152:155], v[56:59], v[232:235]
    ds_read_b64_tr_b16 v[142:143], v9 offset:2048
    v_mfma_f32_16x16x32_bf16 v[236:239], v[156:159], v[56:59], v[236:239]
    buffer_load_dwordx4 v[56:59], v22, s[68:71], s15 offen sc1
    s_waitcnt vmcnt(27)
    v_mfma_f32_16x16x32_bf16 v[240:243], v[144:147], v[60:63], v[240:243]
    v_mfma_f32_16x16x32_bf16 v[244:247], v[148:151], v[60:63], v[244:247]
    v_mfma_f32_16x16x32_bf16 v[248:251], v[152:155], v[60:63], v[248:251]
    v_mfma_f32_16x16x32_bf16 v[252:255], v[156:159], v[60:63], v[252:255]
    buffer_load_dwordx4 v[60:63], v23, s[68:71], s15 offen sc1
    s_waitcnt lgkmcnt(15)
    s_waitcnt vmcnt(23)
    v_mfma_f32_16x16x32_bf16 v[192:195], v[160:163], v[64:67], v[192:195]
    s_waitcnt vmcnt(58)
    v_mfma_f32_16x16x32_bf16 v[196:199], v[164:167], v[64:67], v[196:199]
    ds_read_b64_tr_b16 v[144:145], v6 offset:16384
    v_mfma_f32_16x16x32_bf16 v[200:203], v[168:171], v[64:67], v[200:203]
    ds_read_b64_tr_b16 v[146:147], v6 offset:18432
    v_mfma_f32_16x16x32_bf16 v[204:207], v[172:175], v[64:67], v[204:207]
    s_lshl_b32 s15, s79, 13
    s_add_u32 s15, s15, s95
    s_add_u32 s79, s79, 1
    s_cmp_eq_u32 s79, 7
    s_cselect_b32 s79, 0, s79
    buffer_load_dwordx4 v[64:67], v20, s[68:71], s15 offen sc1
    s_waitcnt vmcnt(23)
    v_mfma_f32_16x16x32_bf16 v[208:211], v[160:163], v[68:71], v[208:211]
    ds_read_b64_tr_b16 v[148:149], v7 offset:16384
    v_mfma_f32_16x16x32_bf16 v[212:215], v[164:167], v[68:71], v[212:215]
    ds_read_b64_tr_b16 v[150:151], v7 offset:18432
    v_mfma_f32_16x16x32_bf16 v[216:219], v[168:171], v[68:71], v[216:219]
    ds_read_b64_tr_b16 v[152:153], v8 offset:16384
    v_mfma_f32_16x16x32_bf16 v[220:223], v[172:175], v[68:71], v[220:223]
    buffer_load_dwordx4 v[68:71], v21, s[68:71], s15 offen sc1
    s_waitcnt vmcnt(23)
    v_mfma_f32_16x16x32_bf16 v[224:227], v[160:163], v[72:75], v[224:227]
    ds_read_b64_tr_b16 v[154:155], v8 offset:18432
    v_mfma_f32_16x16x32_bf16 v[228:231], v[164:167], v[72:75], v[228:231]
    ds_read_b64_tr_b16 v[156:157], v9 offset:16384
    v_mfma_f32_16x16x32_bf16 v[232:235], v[168:171], v[72:75], v[232:235]
    ds_read_b64_tr_b16 v[158:159], v9 offset:18432
    v_mfma_f32_16x16x32_bf16 v[236:239], v[172:175], v[72:75], v[236:239]
    buffer_load_dwordx4 v[72:75], v22, s[68:71], s15 offen sc1
    s_waitcnt vmcnt(23)
    v_mfma_f32_16x16x32_bf16 v[240:243], v[160:163], v[76:79], v[240:243]
    v_mfma_f32_16x16x32_bf16 v[244:247], v[164:167], v[76:79], v[244:247]
    v_mfma_f32_16x16x32_bf16 v[248:251], v[168:171], v[76:79], v[248:251]
    v_mfma_f32_16x16x32_bf16 v[252:255], v[172:175], v[76:79], v[252:255]
    buffer_load_dwordx4 v[76:79], v23, s[68:71], s15 offen sc1
    s_waitcnt lgkmcnt(15)
    s_waitcnt vmcnt(19)
    v_mfma_f32_16x16x32_bf16 v[192:195], v[176:179], v[80:83], v[192:195]
    s_waitcnt vmcnt(28)
    ds_read_b64_tr_b16 v[160:161], v2 offset:32768
    v_mfma_f32_16x16x32_bf16 v[196:199], v[180:183], v[80:83], v[196:199]
    ds_read_b64_tr_b16 v[162:163], v2 offset:34816
    ds_read_b64_tr_b16 v[164:165], v3 offset:32768
    v_mfma_f32_16x16x32_bf16 v[200:203], v[184:187], v[80:83], v[200:203]
    ds_read_b64_tr_b16 v[166:167], v3 offset:34816
    ds_read_b64_tr_b16 v[168:169], v4 offset:32768
    v_mfma_f32_16x16x32_bf16 v[204:207], v[188:191], v[80:83], v[204:207]
    s_lshl_b32 s15, s79, 13
    s_add_u32 s15, s15, s95
    s_add_u32 s79, s79, 1
    s_cmp_eq_u32 s79, 7
    s_cselect_b32 s79, 0, s79
    buffer_load_dwordx4 v[80:83], v20, s[68:71], s15 offen sc1
    s_waitcnt vmcnt(19)
    v_mfma_f32_16x16x32_bf16 v[208:211], v[176:179], v[84:87], v[208:211]
    ds_read_b64_tr_b16 v[170:171], v4 offset:34816
    ds_read_b64_tr_b16 v[172:173], v5 offset:32768
    v_mfma_f32_16x16x32_bf16 v[212:215], v[180:183], v[84:87], v[212:215]
    ds_read_b64_tr_b16 v[174:175], v5 offset:34816
    v_mov_b32 v19, 4
    s_mov_b64 exec, 1
    ds_write_b32 v16, v19
    s_mov_b64 exec, -1
    v_mfma_f32_16x16x32_bf16 v[216:219], v[184:187], v[84:87], v[216:219]
    v_mfma_f32_16x16x32_bf16 v[220:223], v[188:191], v[84:87], v[220:223]
    buffer_load_dwordx4 v[84:87], v21, s[68:71], s15 offen sc1
    s_waitcnt vmcnt(19)
    v_mfma_f32_16x16x32_bf16 v[224:227], v[176:179], v[88:91], v[224:227]
    v_mfma_f32_16x16x32_bf16 v[228:231], v[180:183], v[88:91], v[228:231]
    v_mfma_f32_16x16x32_bf16 v[232:235], v[184:187], v[88:91], v[232:235]
    v_mfma_f32_16x16x32_bf16 v[236:239], v[188:191], v[88:91], v[236:239]
    buffer_load_dwordx4 v[88:91], v22, s[68:71], s15 offen sc1
    s_waitcnt vmcnt(19)
    v_mfma_f32_16x16x32_bf16 v[240:243], v[176:179], v[92:95], v[240:243]
    v_mfma_f32_16x16x32_bf16 v[244:247], v[180:183], v[92:95], v[244:247]
    v_mfma_f32_16x16x32_bf16 v[248:251], v[184:187], v[92:95], v[248:251]
    v_mfma_f32_16x16x32_bf16 v[252:255], v[188:191], v[92:95], v[252:255]
    buffer_load_dwordx4 v[92:95], v23, s[68:71], s15 offen sc1
    s_waitcnt lgkmcnt(15)
    s_waitcnt vmcnt(19)
    v_mfma_f32_16x16x32_bf16 v[192:195], v[96:99], v[112:115], v[192:195]
    s_waitcnt vmcnt(24)
    v_mfma_f32_16x16x32_bf16 v[196:199], v[100:103], v[112:115], v[196:199]
    ds_read_b64_tr_b16 v[176:177], v2 offset:49152
    v_mfma_f32_16x16x32_bf16 v[200:203], v[104:107], v[112:115], v[200:203]
    ds_read_b64_tr_b16 v[178:179], v2 offset:51200
    v_mfma_f32_16x16x32_bf16 v[204:207], v[108:111], v[112:115], v[204:207]
    s_waitcnt vmcnt(18)
    v_mfma_f32_16x16x32_bf16 v[208:211], v[96:99], v[116:119], v[208:211]
    ds_read_b64_tr_b16 v[180:181], v3 offset:49152
    v_mfma_f32_16x16x32_bf16 v[212:215], v[100:103], v[116:119], v[212:215]
    ds_read_b64_tr_b16 v[182:183], v3 offset:51200
    v_mfma_f32_16x16x32_bf16 v[216:219], v[104:107], v[116:119], v[216:219]
    ds_read_b64_tr_b16 v[184:185], v4 offset:49152
    v_mfma_f32_16x16x32_bf16 v[220:223], v[108:111], v[116:119], v[220:223]
    s_waitcnt vmcnt(17)
    v_mfma_f32_16x16x32_bf16 v[224:227], v[96:99], v[120:123], v[224:227]
    ds_read_b64_tr_b16 v[186:187], v4 offset:51200
    v_mfma_f32_16x16x32_bf16 v[228:231], v[100:103], v[120:123], v[228:231]
    ds_read_b64_tr_b16 v[188:189], v5 offset:49152
    v_mfma_f32_16x16x32_bf16 v[232:235], v[104:107], v[120:123], v[232:235]
    ds_read_b64_tr_b16 v[190:191], v5 offset:51200
    v_mfma_f32_16x16x32_bf16 v[236:239], v[108:111], v[120:123], v[236:239]
    s_waitcnt vmcnt(16)
    v_mfma_f32_16x16x32_bf16 v[240:243], v[96:99], v[124:127], v[240:243]
    v_mfma_f32_16x16x32_bf16 v[244:247], v[100:103], v[124:127], v[244:247]
    v_mfma_f32_16x16x32_bf16 v[248:251], v[104:107], v[124:127], v[248:251]
    v_mfma_f32_16x16x32_bf16 v[252:255], v[108:111], v[124:127], v[252:255]
    s_waitcnt lgkmcnt(15)
    s_waitcnt vmcnt(15)
    v_mfma_f32_16x16x32_bf16 v[192:195], v[128:131], v[32:35], v[192:195]
    buffer_load_dwordx2 v[112:113], v31, s[44:47], s92 offen offset:0
    v_mfma_f32_16x16x32_bf16 v[196:199], v[132:135], v[32:35], v[196:199]
    buffer_load_dwordx2 v[114:115], v31, s[44:47], s92 offen offset:32
    v_mfma_f32_16x16x32_bf16 v[200:203], v[136:139], v[32:35], v[200:203]
    buffer_load_dwordx2 v[116:117], v31, s[44:47], s92 offen offset:64
    v_mfma_f32_16x16x32_bf16 v[204:207], v[140:143], v[32:35], v[204:207]
    s_waitcnt vmcnt(17)
    v_mfma_f32_16x16x32_bf16 v[208:211], v[128:131], v[36:39], v[208:211]
    buffer_load_dwordx2 v[118:119], v31, s[44:47], s92 offen offset:96
    v_mfma_f32_16x16x32_bf16 v[212:215], v[132:135], v[36:39], v[212:215]
    v_mfma_f32_16x16x32_bf16 v[216:219], v[136:139], v[36:39], v[216:219]
    v_mfma_f32_16x16x32_bf16 v[220:223], v[140:143], v[36:39], v[220:223]
    s_waitcnt vmcnt(17)
    v_mfma_f32_16x16x32_bf16 v[224:227], v[128:131], v[40:43], v[224:227]
    v_mfma_f32_16x16x32_bf16 v[228:231], v[132:135], v[40:43], v[228:231]
    v_mfma_f32_16x16x32_bf16 v[232:235], v[136:139], v[40:43], v[232:235]
    v_mfma_f32_16x16x32_bf16 v[236:239], v[140:143], v[40:43], v[236:239]
    s_waitcnt vmcnt(16)
    v_mfma_f32_16x16x32_bf16 v[240:243], v[128:131], v[44:47], v[240:243]
    v_mfma_f32_16x16x32_bf16 v[244:247], v[132:135], v[44:47], v[244:247]
    v_mfma_f32_16x16x32_bf16 v[248:251], v[136:139], v[44:47], v[248:251]
    v_mfma_f32_16x16x32_bf16 v[252:255], v[140:143], v[44:47], v[252:255]
    s_waitcnt lgkmcnt(15)
    s_waitcnt vmcnt(15)
    v_mfma_f32_16x16x32_bf16 v[192:195], v[144:147], v[48:51], v[192:195]
    v_mfma_f32_16x16x32_bf16 v[196:199], v[148:151], v[48:51], v[196:199]
    v_mfma_f32_16x16x32_bf16 v[200:203], v[152:155], v[48:51], v[200:203]
    v_mfma_f32_16x16x32_bf16 v[204:207], v[156:159], v[48:51], v[204:207]
    s_waitcnt vmcnt(14)
    v_mfma_f32_16x16x32_bf16 v[208:211], v[144:147], v[52:55], v[208:211]
    v_mfma_f32_16x16x32_bf16 v[212:215], v[148:151], v[52:55], v[212:215]
    v_mfma_f32_16x16x32_bf16 v[216:219], v[152:155], v[52:55], v[216:219]
    v_mfma_f32_16x16x32_bf16 v[220:223], v[156:159], v[52:55], v[220:223]
    s_waitcnt vmcnt(13)
    v_mfma_f32_16x16x32_bf16 v[224:227], v[144:147], v[56:59], v[224:227]
    v_mfma_f32_16x16x32_bf16 v[228:231], v[148:151], v[56:59], v[228:231]
    v_mfma_f32_16x16x32_bf16 v[232:235], v[152:155], v[56:59], v[232:235]
    v_mfma_f32_16x16x32_bf16 v[236:239], v[156:159], v[56:59], v[236:239]
    s_waitcnt vmcnt(12)
    v_mfma_f32_16x16x32_bf16 v[240:243], v[144:147], v[60:63], v[240:243]
    v_mfma_f32_16x16x32_bf16 v[244:247], v[148:151], v[60:63], v[244:247]
    v_mfma_f32_16x16x32_bf16 v[248:251], v[152:155], v[60:63], v[248:251]
    v_mfma_f32_16x16x32_bf16 v[252:255], v[156:159], v[60:63], v[252:255]
    s_waitcnt lgkmcnt(9)
    s_waitcnt vmcnt(11)
    v_mfma_f32_16x16x32_bf16 v[192:195], v[160:163], v[64:67], v[192:195]
    v_add_u32 v2, s98, v1
    v_mfma_f32_16x16x32_bf16 v[196:199], v[164:167], v[64:67], v[196:199]
    v_xor_b32 v3, 4096, v2
    v_mfma_f32_16x16x32_bf16 v[200:203], v[168:171], v[64:67], v[200:203]
    v_xor_b32 v4, 8192, v2
    v_mfma_f32_16x16x32_bf16 v[204:207], v[172:175], v[64:67], v[204:207]
    s_waitcnt vmcnt(10)
    v_mfma_f32_16x16x32_bf16 v[208:211], v[160:163], v[68:71], v[208:211]
    v_xor_b32 v5, 12288, v2
    v_mfma_f32_16x16x32_bf16 v[212:215], v[164:167], v[68:71], v[212:215]
    v_mfma_f32_16x16x32_bf16 v[216:219], v[168:171], v[68:71], v[216:219]
    v_mfma_f32_16x16x32_bf16 v[220:223], v[172:175], v[68:71], v[220:223]
    s_waitcnt vmcnt(9)
    v_mfma_f32_16x16x32_bf16 v[224:227], v[160:163], v[72:75], v[224:227]
    v_mfma_f32_16x16x32_bf16 v[228:231], v[164:167], v[72:75], v[228:231]
    v_mfma_f32_16x16x32_bf16 v[232:235], v[168:171], v[72:75], v[232:235]
    v_mfma_f32_16x16x32_bf16 v[236:239], v[172:175], v[72:75], v[236:239]
    s_waitcnt vmcnt(8)
    v_mfma_f32_16x16x32_bf16 v[240:243], v[160:163], v[76:79], v[240:243]
    v_mfma_f32_16x16x32_bf16 v[244:247], v[164:167], v[76:79], v[244:247]
    v_mfma_f32_16x16x32_bf16 v[248:251], v[168:171], v[76:79], v[248:251]
    v_mfma_f32_16x16x32_bf16 v[252:255], v[172:175], v[76:79], v[252:255]
    s_waitcnt lgkmcnt(0)
    s_waitcnt vmcnt(6)
    v_mfma_f32_16x16x32_bf16 v[208:211], v[176:179], v[84:87], v[208:211]
    v_mfma_f32_16x16x32_bf16 v[212:215], v[180:183], v[84:87], v[212:215]
    v_mfma_f32_16x16x32_bf16 v[216:219], v[184:187], v[84:87], v[216:219]
    v_mfma_f32_16x16x32_bf16 v[220:223], v[188:191], v[84:87], v[220:223]
    s_waitcnt vmcnt(5)
    v_mfma_f32_16x16x32_bf16 v[224:227], v[176:179], v[88:91], v[224:227]
    v_mfma_f32_16x16x32_bf16 v[228:231], v[180:183], v[88:91], v[228:231]
    v_mfma_f32_16x16x32_bf16 v[232:235], v[184:187], v[88:91], v[232:235]
    v_mfma_f32_16x16x32_bf16 v[236:239], v[188:191], v[88:91], v[236:239]
    s_waitcnt vmcnt(4)
    v_mfma_f32_16x16x32_bf16 v[240:243], v[176:179], v[92:95], v[240:243]
    ds_write_b128 v2, v[208:211] offset:16384
    v_mfma_f32_16x16x32_bf16 v[244:247], v[180:183], v[92:95], v[244:247]
    ds_write_b128 v2, v[212:215] offset:17408
    v_mfma_f32_16x16x32_bf16 v[248:251], v[184:187], v[92:95], v[248:251]
    ds_write_b128 v2, v[216:219] offset:18432
    v_mfma_f32_16x16x32_bf16 v[252:255], v[188:191], v[92:95], v[252:255]
    ds_write_b128 v2, v[220:223] offset:19456
    s_waitcnt vmcnt(7)
    v_mfma_f32_16x16x32_bf16 v[192:195], v[176:179], v[80:83], v[192:195]
    ds_write_b128 v2, v[224:227] offset:32768
    v_mfma_f32_16x16x32_bf16 v[196:199], v[180:183], v[80:83], v[196:199]
    ds_write_b128 v2, v[228:231] offset:33792
    v_mfma_f32_16x16x32_bf16 v[200:203], v[184:187], v[80:83], v[200:203]
    ds_write_b128 v2, v[232:235] offset:34816
    v_mfma_f32_16x16x32_bf16 v[204:207], v[188:191], v[80:83], v[204:207]
    ds_write_b128 v2, v[236:239] offset:35840
    ds_write_b128 v2, v[240:243] offset:49152
    ds_write_b128 v2, v[244:247] offset:50176
    ds_write_b128 v2, v[248:251] offset:51200
    ds_write_b128 v2, v[252:255] offset:52224
    s_waitcnt vmcnt(0)
    v_cmp_ne_u32 vcc, s89, v29
    s_cbranch_vccnz L_rs19
L_rr20:
    v_lshlrev_b32 v96, 16, v112
    v_and_b32 v97, 0xffff0000, v112
    v_lshlrev_b32 v98, 16, v113
    v_and_b32 v99, 0xffff0000, v113
    v_lshlrev_b32 v100, 16, v114
    v_and_b32 v101, 0xffff0000, v114
    v_lshlrev_b32 v102, 16, v115
    v_and_b32 v103, 0xffff0000, v115
    v_lshlrev_b32 v104, 16, v116
    v_and_b32 v105, 0xffff0000, v116
    v_lshlrev_b32 v106, 16, v117
    v_and_b32 v107, 0xffff0000, v117
    v_lshlrev_b32 v108, 16, v118
    v_and_b32 v109, 0xffff0000, v118
    v_lshlrev_b32 v110, 16, v119
    v_and_b32 v111, 0xffff0000, v119
    s_waitcnt lgkmcnt(0)
    s_barrier
    ds_read_b128 v[208:211], v3 offset:16384
    ds_read_b128 v[224:227], v4 offset:32768
    ds_read_b128 v[240:243], v5 offset:49152
    ds_read_b64_tr_b16 v[120:121], v30 offset:0
    ds_read_b128 v[212:215], v3 offset:17408
    ds_read_b128 v[228:231], v4 offset:33792
    ds_read_b128 v[244:247], v5 offset:50176
    ds_read_b64_tr_b16 v[122:123], v30 offset:2048
    ds_read_b128 v[216:219], v3 offset:18432
    ds_read_b128 v[232:235], v4 offset:34816
    ds_read_b128 v[248:251], v5 offset:51200
    ds_read_b64_tr_b16 v[124:125], v30 offset:16640
    ds_read_b128 v[220:223], v3 offset:19456
    ds_read_b128 v[236:239], v4 offset:35840
    ds_read_b128 v[252:255], v5 offset:52224
    ds_read_b64_tr_b16 v[126:127], v30 offset:18688
    s_waitcnt lgkmcnt(12)
    v_pk_add_f32 v[192:193], v[192:193], v[208:209]
    v_pk_add_f32 v[224:225], v[224:225], v[240:241]
    v_lshlrev_b32 v32, 16, v120
    v_and_b32 v33, 0xffff0000, v120
    v_pk_add_f32 v[192:193], v[192:193], v[224:225]
    v_pk_add_f32 v[96:97], v[96:97], v[32:33]
    v_pk_add_f32 v[194:195], v[194:195], v[210:211]
    v_pk_add_f32 v[226:227], v[226:227], v[242:243]
    v_lshlrev_b32 v34, 16, v121
    v_and_b32 v35, 0xffff0000, v121
    v_pk_add_f32 v[194:195], v[194:195], v[226:227]
    v_pk_add_f32 v[98:99], v[98:99], v[34:35]
    v_pk_fma_f32 v[96:97], v[192:193], v[28:29], v[96:97] op_sel:[0,0,0] op_sel_hi:[1,0,1]
    v_pk_fma_f32 v[98:99], v[194:195], v[28:29], v[98:99] op_sel:[0,0,0] op_sel_hi:[1,0,1]
    v_cvt_pk_bf16_f32 v40, v96, v97
    v_cvt_pk_bf16_f32 v41, v98, v99
    buffer_store_dwordx2 v[40:41], v31, s[60:63], s92 offen offset:0
    s_waitcnt lgkmcnt(8)
    v_pk_add_f32 v[196:197], v[196:197], v[212:213]
    v_pk_add_f32 v[228:229], v[228:229], v[244:245]
    v_lshlrev_b32 v32, 16, v122
    v_and_b32 v33, 0xffff0000, v122
    v_pk_add_f32 v[196:197], v[196:197], v[228:229]
    v_pk_add_f32 v[100:101], v[100:101], v[32:33]
    v_pk_add_f32 v[198:199], v[198:199], v[214:215]
    v_pk_add_f32 v[230:231], v[230:231], v[246:247]
    v_lshlrev_b32 v34, 16, v123
    v_and_b32 v35, 0xffff0000, v123
    v_pk_add_f32 v[198:199], v[198:199], v[230:231]
    v_pk_add_f32 v[102:103], v[102:103], v[34:35]
    v_pk_fma_f32 v[100:101], v[196:197], v[28:29], v[100:101] op_sel:[0,0,0] op_sel_hi:[1,0,1]
    v_pk_fma_f32 v[102:103], v[198:199], v[28:29], v[102:103] op_sel:[0,0,0] op_sel_hi:[1,0,1]
    v_cvt_pk_bf16_f32 v42, v100, v101
    v_cvt_pk_bf16_f32 v43, v102, v103
    buffer_store_dwordx2 v[42:43], v31, s[60:63], s92 offen offset:32
    s_waitcnt lgkmcnt(4)
    v_pk_add_f32 v[200:201], v[200:201], v[216:217]
    v_pk_add_f32 v[232:233], v[232:233], v[248:249]
    v_lshlrev_b32 v32, 16, v124
    v_and_b32 v33, 0xffff0000, v124
    v_pk_add_f32 v[200:201], v[200:201], v[232:233]
    v_pk_add_f32 v[104:105], v[104:105], v[32:33]
    v_pk_add_f32 v[202:203], v[202:203], v[218:219]
    v_pk_add_f32 v[234:235], v[234:235], v[250:251]
    v_lshlrev_b32 v34, 16, v125
    v_and_b32 v35, 0xffff0000, v125
    v_pk_add_f32 v[202:203], v[202:203], v[234:235]
    v_pk_add_f32 v[106:107], v[106:107], v[34:35]
    v_pk_fma_f32 v[104:105], v[200:201], v[28:29], v[104:105] op_sel:[0,0,0] op_sel_hi:[1,0,1]
    v_pk_fma_f32 v[106:107], v[202:203], v[28:29], v[106:107] op_sel:[0,0,0] op_sel_hi:[1,0,1]
    v_cvt_pk_bf16_f32 v44, v104, v105
    v_cvt_pk_bf16_f32 v45, v106, v107
    buffer_store_dwordx2 v[44:45], v31, s[60:63], s92 offen offset:64
    s_waitcnt lgkmcnt(0)
    v_pk_add_f32 v[204:205], v[204:205], v[220:221]
    v_pk_add_f32 v[236:237], v[236:237], v[252:253]
    v_lshlrev_b32 v32, 16, v126
    v_and_b32 v33, 0xffff0000, v126
    v_pk_add_f32 v[204:205], v[204:205], v[236:237]
    v_pk_add_f32 v[108:109], v[108:109], v[32:33]
    v_pk_add_f32 v[206:207], v[206:207], v[222:223]
    v_pk_add_f32 v[238:239], v[238:239], v[254:255]
    v_lshlrev_b32 v34, 16, v127
    v_and_b32 v35, 0xffff0000, v127
    v_pk_add_f32 v[206:207], v[206:207], v[238:239]
    v_pk_add_f32 v[110:111], v[110:111], v[34:35]
    v_pk_fma_f32 v[108:109], v[204:205], v[28:29], v[108:109] op_sel:[0,0,0] op_sel_hi:[1,0,1]
    v_pk_fma_f32 v[110:111], v[206:207], v[28:29], v[110:111] op_sel:[0,0,0] op_sel_hi:[1,0,1]
    v_cvt_pk_bf16_f32 v46, v108, v109
    v_cvt_pk_bf16_f32 v47, v110, v111
    buffer_store_dwordx2 v[46:47], v31, s[60:63], s92 offen offset:96
    s_endpgm
L_X:
    global_load_dwordx4 v[160:163], v2, s[16:17]
    global_load_dwordx4 v[164:167], v2, s[16:17] offset:1024
    global_load_ushort v89, v21, s[28:29]
    s_or_b32 s13, s2, s12
    s_cmp_lg_u32 s13, 0
    s_cbranch_scc1 L_nz22
    s_or_b32 s13, s80, 1
    v_mov_b32 v19, s13
    s_mov_b64 exec, 1
    global_store_dword v18, v19, s[40:41] sc1
    s_mov_b64 exec, -1
L_nz22:
    s_barrier
    s_mov_b64 s[44:45], s[16:17]
    s_mov_b64 s[48:49], s[16:17]
    s_bitcmp1_b32 s3, 0
    s_cselect_b32 s52, s34, s32
    s_cselect_b32 s53, s35, s33
    s_mov_b64 s[68:69], s[42:43]
    s_mov_b64 s[72:73], s[42:43]
    s_mov_b64 s[56:57], s[36:37]
    s_mov_b64 s[60:61], s[38:39]
    s_mov_b64 s[64:65], s[40:41]
    v_xor_b32 v28, v24, v23
    v_lshlrev_b32 v28, 4, v28
    v_lshl_add_u32 v4, v22, 10, v28
    s_lshl_b32 s13, s6, 17
    s_lshl_b32 s14, s12, 15
    s_add_u32 s13, s13, s14
    v_add_u32 v4, s13, v4
    v_xor_b32 v5, 64, v4
    v_add_u32 v6, 14336, v4
    v_add_u32 v7, 21504, v5
    v_add_u32 v5, 7168, v5
    v_and_b32 v28, 1, v24
    v_lshlrev_b32 v28, 1, v28
    v_xor_b32 v28, v28, v23
    v_lshlrev_b32 v28, 4, v28
    v_mul_u32_u24 v29, 3584, v22
    s_lshl_b32 s13, s7, 8
    s_lshl_b32 s14, s97, 7
    s_add_u32 s13, s13, s14
    v_add_u32 v29, s13, v29
    v_add_u32 v8, v29, v28
    v_xor_b32 v28, 64, v28
    v_add_u32 v9, v29, v28
    v_add_u32 v10, 55296, v8
    v_add_u32 v11, 82944, v9
    v_add_u32 v9, 27648, v9
    s_lshl_b32 s100, s96, 13
    s_lshl_b32 s13, s97, 12
    s_add_u32 s100, s100, s13
    s_movk_i32 s76, 128
    s_and_b32 s84, s11, 6
    s_cmp_lt_u32 s5, 28
    s_cbranch_scc1 L_nsp23
    s_mov_b64 s[48:49], s[36:37]
    s_mov_b64 s[52:53], s[36:37]
    s_mov_b32 s50, 0
    s_mov_b32 s54, 0
    s_mov_b32 s84, s4
    s_mov_b32 s76, 229376
    s_and_b32 s13, s5, 3
    s_lshl_b32 s13, s13, 2
    s_add_u32 s13, s13, s12
    s_lshl_b32 s14, s13, 12
    v_add_u32 v8, s14, v1
    s_lshr_b32 s14, s13, 3
    s_mul_i32 s14, s14, 28
    s_and_b32 s13, s13, 7
    s_add_u32 s14, s14, s13
    s_add_u32 s14, s14, 16
    s_lshl_b32 s14, s14, 12
    v_add_u32 v4, s14, v1
    v_mov_b32 v5, v4
    v_mov_b32 v9, v8
    v_mov_b32 v6, v4
    v_mov_b32 v10, v8
    v_mov_b32 v7, v4
    v_mov_b32 v11, v8
L_nsp23:
    s_xor_b32 s81, s93, 0
    s_add_u32 s81, s81, s84
    s_and_b32 s81, s81, 7
    s_mul_i32 s81, s81, s76
    s_add_u32 m0, s98, 65536
    s_nop 0
    buffer_load_dwordx4 v4, s[48:51], s81 offen offset:0 lds
    buffer_load_dwordx4 v5, s[48:51], s81 offen offset:1024 lds
    buffer_load_dwordx4 v6, s[48:51], s81 offen offset:2048 lds
    buffer_load_dwordx4 v7, s[48:51], s81 offen offset:3072 lds
    s_xor_b32 s81, s93, 0
    s_add_u32 s81, s81, s84
    s_and_b32 s81, s81, 7
    s_mul_i32 s81, s81, 229376
    s_add_u32 m0, s100, 0
    s_nop 0
    buffer_load_dwordx4 v8, s[52:55], s81 offen offset:0 lds
    buffer_load_dwordx4 v9, s[52:55], s81 offen offset:1024 lds
    buffer_load_dwordx4 v10, s[52:55], s81 offen offset:2048 lds
    buffer_load_dwordx4 v11, s[52:55], s81 offen offset:3072 lds
    s_mul_i32 s13, s12, 2176
    s_add_u32 s13, s13, 154272
    v_add_u32 v200, s13, v1
    v_mov_b32 v201, s13
    v_min_u32 v112, 7, v27
    v_lshlrev_b32 v112, 3, v112
    s_mov_b32 s14, 0x0c121110
    s_mov_b32 s15, 0x14141413
    v_lshrrev_b64 v[114:115], v112, s[14:15]
    v_and_b32 v114, 0xff, v114
    s_cmp_eq_u32 s97, 0
    s_cselect_b64 vcc, -1, 0
    v_cndmask_b32 v112, v114, v27, vcc
    v_mul_u32_u24 v112, 528, v112
    v_lshl_add_u32 v112, v24, 4, v112
    s_mul_i32 s13, s96, 11088
    s_add_u32 s13, s13, 98304
    v_add_u32 v112, s13, v112
    v_mul_u32_u24 v113, 528, v27
    v_lshl_add_u32 v113, v24, 4, v113
    s_mul_i32 s13, s96, 16896
    s_add_u32 s13, s13, 120480
    v_add_u32 v113, s13, v113
    v_lshlrev_b32 v118, 4, v24
    s_cmp_eq_u32 s97, 0
    s_cselect_b32 s14, 0x00080000, 0x0
    s_cselect_b32 s15, 0x0a000200, 0x0
    s_cselect_b32 s13, 0, 0x04080400
    s_or_b32 s14, s14, s13
    s_cmp_eq_u32 s97, 0
    s_cselect_b32 s13, 0, 0x08020802
    s_or_b32 s15, s15, s13
    v_lshrrev_b64 v[114:115], v118, s[14:15]
    v_and_b32 v114, 0xffff, v114
    s_cmp_eq_u32 s97, 0
    s_cselect_b32 s14, 0x00020002, 0x0
    s_cselect_b32 s15, 0x02000004, 0x0
    s_cselect_b32 s13, 0, 0x02000200
    s_or_b32 s14, s14, s13
    s_or_b32 s15, s15, s13
    v_lshrrev_b64 v[118:119], v118, s[14:15]
    v_and_b32 v118, 0xffff, v118
    s_mul_i32 s13, s96, 4752
    s_add_u32 s13, s13, 154288
    v_lshl_add_u32 v114, v27, 4, v114
    v_add_u32 v115, v114, v118
    v_add_u32 v116, v115, v118
    v_add_u32 v117, v116, v118
    v_lshrrev_b32 v118, 7, v114
    v_lshl_add_u32 v114, v118, 2, v114
    v_add_u32 v114, s13, v114
    v_lshrrev_b32 v118, 7, v115
    v_lshl_add_u32 v115, v118, 2, v115
    v_add_u32 v115, s13, v115
    v_lshrrev_b32 v118, 7, v116
    v_lshl_add_u32 v116, v118, 2, v116
    v_add_u32 v116, s13, v116
    v_lshrrev_b32 v118, 7, v117
    v_lshl_add_u32 v117, v118, 2, v117
    v_add_u32 v117, s13, v117
    v_lshlrev_b32 v28, 10, v24
    v_lshl_add_u32 v28, v25, 7, v28
    v_lshl_add_u32 v28, v26, 3, v28
    v_and_b32 v29, 1, v24
    v_lshlrev_b32 v29, 1, v29
    v_lshrrev_b32 v30, 1, v25
    v_or_b32 v29, v29, v30
    s_and_b32 s15, s5, 3
    v_xor_b32 v29, s15, v29
    v_lshl_add_u32 v80, v29, 5, v28
    v_add_u32 v80, s100, v80
    s_lshl_b32 s13, s7, 2
    s_add_u32 s13, s13, s12
    s_lshl_b32 s13, s13, 11
    s_add_u32 s94, s13, 11534336
    s_lshl_b32 s14, s11, 8
    s_lshl_b32 s15, s15, 3
    s_add_u32 s14, s14, s15
    s_add_u32 s101, s94, s14
    v_lshlrev_b32 v79, 5, v0
    v_mov_b32 v60, 0
    v_mov_b32 v56, 0x3f803f80
    v_mov_b32 v61, 0
    v_mov_b32 v57, 0x3f803f80
    v_mov_b32 v62, 0
    v_mov_b32 v58, 0x3f803f80
    v_mov_b32 v63, 0
    v_mov_b32 v59, 0x3f803f80
    s_waitcnt vmcnt(8)
    buffer_load_dword v84, v18, s[64:67], 0 offen sc1
    v_lshlrev_b32 v168, 16, v160
    v_and_b32 v169, 0xffff0000, v160
    v_lshlrev_b32 v170, 16, v161
    v_and_b32 v171, 0xffff0000, v161
    v_lshlrev_b32 v172, 16, v162
    v_and_b32 v173, 0xffff0000, v162
    v_lshlrev_b32 v174, 16, v163
    v_and_b32 v175, 0xffff0000, v163
    v_lshlrev_b32 v176, 16, v164
    v_and_b32 v177, 0xffff0000, v164
    v_lshlrev_b32 v178, 16, v165
    v_and_b32 v179, 0xffff0000, v165
    v_lshlrev_b32 v180, 16, v166
    v_and_b32 v181, 0xffff0000, v166
    v_lshlrev_b32 v182, 16, v167
    v_and_b32 v183, 0xffff0000, v167
    v_pk_add_f32 v[184:185], v[168:169], v[170:171]
    v_pk_add_f32 v[186:187], v[172:173], v[174:175]
    v_pk_add_f32 v[184:185], v[184:185], v[186:187]
    v_add_f32 v184, v184, v185
    v_pk_add_f32 v[188:189], v[176:177], v[178:179]
    v_pk_add_f32 v[190:191], v[180:181], v[182:183]
    v_pk_add_f32 v[188:189], v[188:189], v[190:191]
    v_add_f32 v188, v188, v189
    v_add_f32_dpp v184, v184, v184 quad_perm:[1,0,3,2] row_mask:0xf bank_mask:0xf
    s_nop 0
    v_add_f32_dpp v188, v188, v188 quad_perm:[1,0,3,2] row_mask:0xf bank_mask:0xf
    v_add_f32_dpp v184, v184, v184 quad_perm:[2,3,0,1] row_mask:0xf bank_mask:0xf
    s_nop 0
    v_add_f32_dpp v188, v188, v188 quad_perm:[2,3,0,1] row_mask:0xf bank_mask:0xf
    v_add_f32_dpp v184, v184, v184 row_half_mirror row_mask:0xf bank_mask:0xf
    s_nop 0
    v_add_f32_dpp v188, v188, v188 row_half_mirror row_mask:0xf bank_mask:0xf
    v_add_f32_dpp v184, v184, v184 row_mirror row_mask:0xf bank_mask:0xf
    s_nop 0
    v_add_f32_dpp v188, v188, v188 row_mirror row_mask:0xf bank_mask:0xf
    v_add_f32_dpp v184, v184, v184 row_bcast:15 row_mask:0xa bank_mask:0xf
    s_nop 0
    v_add_f32_dpp v188, v188, v188 row_bcast:15 row_mask:0xa bank_mask:0xf
    s_xor_b32 s81, s93, 0
    s_add_u32 s81, s81, s84
    s_and_b32 s81, s81, 7
    s_mul_i32 s81, s81, 229376
    s_add_u32 s81, s81, 114688
    s_add_u32 m0, s100, 16384
    s_nop 0
    buffer_load_dwordx4 v8, s[52:55], s81 offen offset:0 lds
    v_add_f32_dpp v184, v184, v184 row_bcast:31 row_mask:0xc bank_mask:0xf
    v_add_f32_dpp v188, v188, v188 row_bcast:31 row_mask:0xc bank_mask:0xf
    v_readlane_b32 s13, v184, 63
    v_readlane_b32 s14, v188, 63
    v_mov_b32 v192, 0x3b000000
    v_mul_f32 v185, s13, v192
    v_mul_f32 v189, s14, v192
    v_pk_add_f32 v[194:195], v[168:169], v[184:185] op_sel:[0,1] op_sel_hi:[1,1] neg_lo:[0,1] neg_hi:[0,1]
    v_pk_add_f32 v[198:199], v[176:177], v[188:189] op_sel:[0,1] op_sel_hi:[1,1] neg_lo:[0,1] neg_hi:[0,1]
    v_pk_mul_f32 v[186:187], v[194:195], v[194:195]
    v_pk_mul_f32 v[190:191], v[198:199], v[198:199]
    v_pk_add_f32 v[194:195], v[170:171], v[184:185] op_sel:[0,1] op_sel_hi:[1,1] neg_lo:[0,1] neg_hi:[0,1]
    v_pk_add_f32 v[198:199], v[178:179], v[188:189] op_sel:[0,1] op_sel_hi:[1,1] neg_lo:[0,1] neg_hi:[0,1]
    v_pk_fma_f32 v[186:187], v[194:195], v[194:195], v[186:187]
    v_pk_fma_f32 v[190:191], v[198:199], v[198:199], v[190:191]
    v_pk_add_f32 v[194:195], v[172:173], v[184:185] op_sel:[0,1] op_sel_hi:[1,1] neg_lo:[0,1] neg_hi:[0,1]
    v_pk_add_f32 v[198:199], v[180:181], v[188:189] op_sel:[0,1] op_sel_hi:[1,1] neg_lo:[0,1] neg_hi:[0,1]
    v_pk_fma_f32 v[186:187], v[194:195], v[194:195], v[186:187]
    v_pk_fma_f32 v[190:191], v[198:199], v[198:199], v[190:191]
    v_pk_add_f32 v[194:195], v[174:175], v[184:185] op_sel:[0,1] op_sel_hi:[1,1] neg_lo:[0,1] neg_hi:[0,1]
    v_pk_add_f32 v[198:199], v[182:183], v[188:189] op_sel:[0,1] op_sel_hi:[1,1] neg_lo:[0,1] neg_hi:[0,1]
    v_pk_fma_f32 v[186:187], v[194:195], v[194:195], v[186:187]
    v_pk_fma_f32 v[190:191], v[198:199], v[198:199], v[190:191]
    v_add_f32 v184, v186, v187
    v_add_f32 v188, v190, v191
    s_nop 0
    v_add_f32_dpp v184, v184, v184 quad_perm:[1,0,3,2] row_mask:0xf bank_mask:0xf
    v_add_f32_dpp v188, v188, v188 quad_perm:[1,0,3,2] row_mask:0xf bank_mask:0xf
    s_nop 0
    v_add_f32_dpp v184, v184, v184 quad_perm:[2,3,0,1] row_mask:0xf bank_mask:0xf
    v_add_f32_dpp v188, v188, v188 quad_perm:[2,3,0,1] row_mask:0xf bank_mask:0xf
    s_nop 0
    v_add_f32_dpp v184, v184, v184 row_half_mirror row_mask:0xf bank_mask:0xf
    v_add_f32_dpp v188, v188, v188 row_half_mirror row_mask:0xf bank_mask:0xf
    s_nop 0
    v_add_f32_dpp v184, v184, v184 row_mirror row_mask:0xf bank_mask:0xf
    v_add_f32_dpp v188, v188, v188 row_mirror row_mask:0xf bank_mask:0xf
    s_nop 0
    v_add_f32_dpp v184, v184, v184 row_bcast:15 row_mask:0xa bank_mask:0xf
    v_add_f32_dpp v188, v188, v188 row_bcast:15 row_mask:0xa bank_mask:0xf
    buffer_load_dwordx4 v9, s[52:55], s81 offen offset:1024 lds
    v_add_f32_dpp v184, v184, v184 row_bcast:31 row_mask:0xc bank_mask:0xf
    v_add_f32_dpp v188, v188, v188 row_bcast:31 row_mask:0xc bank_mask:0xf
    v_readlane_b32 s13, v184, 63
    v_readlane_b32 s14, v188, 63
    s_nop 0
    v_mul_f32 v184, s13, v192
    v_mul_f32 v188, s14, v192
    v_cvt_pk_bf16_f32 v193, v184, v188
    v_cvt_pk_bf16_f32 v194, v185, v189
    v_lshlrev_b32 v184, 16, v193
    v_and_b32 v188, 0xffff0000, v193
    v_lshlrev_b32 v185, 16, v194
    v_and_b32 v189, 0xffff0000, v194
    v_add_f32 v184, 0x3727c5ac, v184
    v_add_f32 v188, 0x3727c5ac, v188
    v_cvt_pk_bf16_f32 v193, v184, v188
    v_lshlrev_b32 v184, 16, v193
    v_and_b32 v188, 0xffff0000, v193
    v_sqrt_f32 v184, v184
    v_sqrt_f32 v188, v188
    s_nop 0
    v_cvt_pk_bf16_f32 v193, v184, v188
    v_lshlrev_b32 v184, 16, v193
    v_and_b32 v188, 0xffff0000, v193
    v_rcp_f32 v184, v184
    v_rcp_f32 v188, v188
    v_cvt_pk_bf16_f32 v196, -v185, -v185
    v_cvt_pk_bf16_f32 v198, -v189, -v189
    v_mul_f32 v197, v184, v184
    v_mul_f32 v199, v188, v188
    v_pk_add_f32 v[168:169], v[168:169], v[184:185] op_sel:[0,1] op_sel_hi:[1,1] neg_lo:[0,1] neg_hi:[0,1]
    v_cvt_pk_bf16_f32 v169, v168, v169
    v_lshlrev_b32 v168, 16, v169
    v_and_b32 v169, 0xffff0000, v169
    v_pk_mul_f32 v[168:169], v[168:169], v[184:185] op_sel:[0,0] op_sel_hi:[1,0]
    v_cvt_pk_bf16_f32 v169, v168, v169
    v_lshlrev_b32 v168, 16, v169
    buffer_load_dwordx4 v10, s[52:55], s81 offen offset:2048 lds
    v_and_b32 v169, 0xffff0000, v169
    v_cvt_pk_f16_f32 v160, v168, v169
    v_pk_add_f32 v[176:177], v[176:177], v[188:189] op_sel:[0,1] op_sel_hi:[1,1] neg_lo:[0,1] neg_hi:[0,1]
    v_cvt_pk_bf16_f32 v177, v176, v177
    v_lshlrev_b32 v176, 16, v177
    v_and_b32 v177, 0xffff0000, v177
    v_pk_mul_f32 v[176:177], v[176:177], v[188:189] op_sel:[0,0] op_sel_hi:[1,0]
    v_cvt_pk_bf16_f32 v177, v176, v177
    v_lshlrev_b32 v176, 16, v177
    v_and_b32 v177, 0xffff0000, v177
    v_cvt_pk_f16_f32 v164, v176, v177
    v_pk_add_f32 v[170:171], v[170:171], v[184:185] op_sel:[0,1] op_sel_hi:[1,1] neg_lo:[0,1] neg_hi:[0,1]
    v_cvt_pk_bf16_f32 v171, v170, v171
    v_lshlrev_b32 v170, 16, v171
    v_and_b32 v171, 0xffff0000, v171
    v_pk_mul_f32 v[170:171], v[170:171], v[184:185] op_sel:[0,0] op_sel_hi:[1,0]
    v_cvt_pk_bf16_f32 v171, v170, v171
    v_lshlrev_b32 v170, 16, v171
    v_and_b32 v171, 0xffff0000, v171
    v_cvt_pk_f16_f32 v161, v170, v171
    v_pk_add_f32 v[178:179], v[178:179], v[188:189] op_sel:[0,1] op_sel_hi:[1,1] neg_lo:[0,1] neg_hi:[0,1]
    v_cvt_pk_bf16_f32 v179, v178, v179
    v_lshlrev_b32 v178, 16, v179
    v_and_b32 v179, 0xffff0000, v179
    v_pk_mul_f32 v[178:179], v[178:179], v[188:189] op_sel:[0,0] op_sel_hi:[1,0]
    v_cvt_pk_bf16_f32 v179, v178, v179
    v_lshlrev_b32 v178, 16, v179
    v_and_b32 v179, 0xffff0000, v179
    v_cvt_pk_f16_f32 v165, v178, v179
    v_pk_add_f32 v[172:173], v[172:173], v[184:185] op_sel:[0,1] op_sel_hi:[1,1] neg_lo:[0,1] neg_hi:[0,1]
    v_cvt_pk_bf16_f32 v173, v172, v173
    v_lshlrev_b32 v172, 16, v173
    v_and_b32 v173, 0xffff0000, v173
    v_pk_mul_f32 v[172:173], v[172:173], v[184:185] op_sel:[0,0] op_sel_hi:[1,0]
    v_cvt_pk_bf16_f32 v173, v172, v173
    buffer_load_dwordx4 v11, s[52:55], s81 offen offset:3072 lds
    v_lshlrev_b32 v172, 16, v173
    v_and_b32 v173, 0xffff0000, v173
    v_cvt_pk_f16_f32 v162, v172, v173
    v_pk_add_f32 v[180:181], v[180:181], v[188:189] op_sel:[0,1] op_sel_hi:[1,1] neg_lo:[0,1] neg_hi:[0,1]
    v_cvt_pk_bf16_f32 v181, v180, v181
    v_lshlrev_b32 v180, 16, v181
    v_and_b32 v181, 0xffff0000, v181
    v_pk_mul_f32 v[180:181], v[180:181], v[188:189] op_sel:[0,0] op_sel_hi:[1,0]
    v_cvt_pk_bf16_f32 v181, v180, v181
    v_lshlrev_b32 v180, 16, v181
    v_and_b32 v181, 0xffff0000, v181
    v_cvt_pk_f16_f32 v166, v180, v181
    v_pk_add_f32 v[174:175], v[174:175], v[184:185] op_sel:[0,1] op_sel_hi:[1,1] neg_lo:[0,1] neg_hi:[0,1]
    v_cvt_pk_bf16_f32 v175, v174, v175
    v_lshlrev_b32 v174, 16, v175
    v_and_b32 v175, 0xffff0000, v175
    v_pk_mul_f32 v[174:175], v[174:175], v[184:185] op_sel:[0,0] op_sel_hi:[1,0]
    v_cvt_pk_bf16_f32 v175, v174, v175
    v_lshlrev_b32 v174, 16, v175
    v_and_b32 v175, 0xffff0000, v175
    v_cvt_pk_f16_f32 v163, v174, v175
    v_pk_add_f32 v[182:183], v[182:183], v[188:189] op_sel:[0,1] op_sel_hi:[1,1] neg_lo:[0,1] neg_hi:[0,1]
    v_cvt_pk_bf16_f32 v183, v182, v183
    v_lshlrev_b32 v182, 16, v183
    v_and_b32 v183, 0xffff0000, v183
    v_pk_mul_f32 v[182:183], v[182:183], v[188:189] op_sel:[0,0] op_sel_hi:[1,0]
    v_cvt_pk_bf16_f32 v183, v182, v183
    v_lshlrev_b32 v182, 16, v183
    v_and_b32 v183, 0xffff0000, v183
    v_cvt_pk_f16_f32 v167, v182, v183
    ds_write_b128 v200, v[160:163]
    ds_write_b128 v200, v[164:167] offset:1088
    s_mov_b64 exec, 1
    ds_write_b64 v201, v[196:197] offset:1024
    ds_write_b64 v201, v[198:199] offset:2112
    s_mov_b64 exec, -1
    v_readfirstlane_b32 s77, v89
    s_nop 1
    s_lshl_b32 s77, s77, 16
    s_xor_b32 s81, s93, 1
    s_add_u32 s81, s81, s84
    s_and_b32 s81, s81, 7
    s_mul_i32 s81, s81, s76
    s_add_u32 m0, s98, 81920
    s_nop 0
    buffer_load_dwordx4 v4, s[48:51], s81 offen offset:0 lds
    buffer_load_dwordx4 v5, s[48:51], s81 offen offset:1024 lds
    buffer_load_dwordx4 v6, s[48:51], s81 offen offset:2048 lds
    buffer_load_dwordx4 v7, s[48:51], s81 offen offset:3072 lds
    s_xor_b32 s81, s93, 1
    s_add_u32 s81, s81, s84
    s_and_b32 s81, s81, 7
    s_mul_i32 s81, s81, 229376
    s_add_u32 m0, s100, 32768
    s_nop 0
    buffer_load_dwordx4 v8, s[52:55], s81 offen offset:0 lds
    buffer_load_dwordx4 v9, s[52:55], s81 offen offset:1024 lds
    buffer_load_dwordx4 v10, s[52:55], s81 offen offset:2048 lds
    buffer_load_dwordx4 v11, s[52:55], s81 offen offset:3072 lds
    s_waitcnt lgkmcnt(0)
    s_waitcnt vmcnt(13)
    s_barrier
    s_setprio 0
    s_cmp_lt_u32 s5, 28
    s_cselect_b32 s50, s50, 1835008
    s_cselect_b32 s54, s54, 1835008
    s_xor_b32 s81, s93, 1
    s_add_u32 s81, s81, s84
    s_and_b32 s81, s81, 7
    s_mul_i32 s81, s81, 229376
    s_add_u32 s81, s81, 114688
    s_add_u32 m0, s100, 49152
    s_nop 0
    buffer_load_dwordx4 v8, s[52:55], s81 offen offset:0 lds
    ds_read_b64_tr_b16 v[92:93], v80 offset:0
    ds_read_b64_tr_b16 v[94:95], v80 offset:512
    buffer_load_dwordx4 v9, s[52:55], s81 offen offset:1024 lds
    ds_read_b128 v[128:131], v112 offset:0
    ds_read_b128 v[140:143], v112 offset:64
    ds_read_b128 v[152:155], v112 offset:128
    buffer_load_dwordx4 v10, s[52:55], s81 offen offset:2048 lds
    ds_read_b128 v[164:167], v112 offset:192
    ds_read_b128 v[176:179], v112 offset:256
    buffer_load_dwordx4 v11, s[52:55], s81 offen offset:3072 lds
    ds_read_b128 v[188:191], v112 offset:320
    ds_read_b128 v[200:203], v112 offset:384
    ds_read_b128 v[212:215], v112 offset:448
    s_waitcnt vmcnt(12)
    s_waitcnt lgkmcnt(0)
    s_barrier
    s_xor_b32 s81, s93, 2
    s_add_u32 s81, s81, s84
    s_and_b32 s81, s81, 7
    s_mul_i32 s81, s81, s76
    s_add_u32 m0, s98, 98304
    s_nop 0
    buffer_load_dwordx4 v4, s[48:51], s81 offen offset:0 lds
    ds_read_b64_tr_b16 v[96:97], v80 offset:16384
    buffer_load_dwordx4 v5, s[48:51], s81 offen offset:1024 lds
    ds_read_b64_tr_b16 v[98:99], v80 offset:16896
    buffer_load_dwordx4 v6, s[48:51], s81 offen offset:2048 lds
    s_waitcnt vmcnt(19)
    buffer_load_dwordx4 v7, s[48:51], s81 offen offset:3072 lds
    v_cmp_eq_u32 vcc, 0, v84
    s_xor_b32 s81, s93, 2
    s_add_u32 s81, s81, s84
    s_and_b32 s81, s81, 7
    s_mul_i32 s81, s81, 229376
    s_add_u32 m0, s100, 0
    s_nop 0
    buffer_load_dwordx4 v8, s[52:55], s81 offen offset:0 lds
    s_cbranch_vccnz L_ns24
L_pl25:
    buffer_load_dwordx4 v9, s[52:55], s81 offen offset:1024 lds
    v_mov_b32 v85, 163832
    buffer_load_dwordx4 v10, s[52:55], s81 offen offset:2048 lds
    v_readfirstlane_b32 s89, v84
    buffer_load_dwordx4 v11, s[52:55], s81 offen offset:3072 lds
    s_mov_b64 exec, 1
    ds_write_b32 v85, v84
    s_mov_b64 exec, -1
    s_waitcnt vmcnt(12)
    s_waitcnt vmcnt(16)
    s_waitcnt lgkmcnt(0)
    s_barrier
    s_xor_b32 s81, s93, 2
    s_add_u32 s81, s81, s84
    s_and_b32 s81, s81, 7
    s_mul_i32 s81, s81, 229376
    s_add_u32 s81, s81, 114688
    s_add_u32 m0, s100, 16384
    s_nop 0
    buffer_load_dwordx4 v8, s[52:55], s81 offen offset:0 lds
    buffer_load_dwordx4 v9, s[52:55], s81 offen offset:1024 lds
    buffer_load_dwordx4 v10, s[52:55], s81 offen offset:2048 lds
    ds_read_b64_tr_b16 v[100:101], v80 offset:32768
    buffer_load_dwordx4 v11, s[52:55], s81 offen offset:3072 lds
    s_xor_b32 s81, s93, 3
    s_add_u32 s81, s81, s84
    s_and_b32 s81, s81, 7
    s_mul_i32 s81, s81, s76
    s_add_u32 m0, s98, 65536
    s_nop 0
    buffer_load_dwordx4 v4, s[48:51], s81 offen offset:0 lds
    buffer_load_dwordx4 v5, s[48:51], s81 offen offset:1024 lds
    ds_read_b64_tr_b16 v[102:103], v80 offset:33280
    s_waitcnt vmcnt(14)
    s_waitcnt lgkmcnt(0)
    s_barrier
    s_xor_b32 s81, s93, 3
    s_add_u32 s81, s81, s84
    s_and_b32 s81, s81, 7
    s_mul_i32 s81, s81, 229376
    s_add_u32 m0, s100, 32768
    s_nop 0
    buffer_load_dwordx4 v8, s[52:55], s81 offen offset:0 lds
    buffer_load_dwordx4 v9, s[52:55], s81 offen offset:1024 lds
    buffer_load_dwordx4 v10, s[52:55], s81 offen offset:2048 lds
    ds_read_b64_tr_b16 v[104:105], v80 offset:49152
    buffer_load_dwordx4 v11, s[52:55], s81 offen offset:3072 lds
    s_xor_b32 s81, s93, 3
    s_add_u32 s81, s81, s84
    s_and_b32 s81, s81, 7
    s_mul_i32 s81, s81, s76
    s_add_u32 m0, s98, 65536
    s_nop 0
    buffer_load_dwordx4 v6, s[48:51], s81 offen offset:2048 lds
    buffer_load_dwordx4 v7, s[48:51], s81 offen offset:3072 lds
    ds_read_b64_tr_b16 v[106:107], v80 offset:49664
    s_waitcnt vmcnt(12)
    s_waitcnt vmcnt(16)
    s_waitcnt lgkmcnt(0)
    s_barrier
    s_xor_b32 s81, s93, 3
    s_add_u32 s81, s81, s84
    s_and_b32 s81, s81, 7
    s_mul_i32 s81, s81, 229376
    s_add_u32 s81, s81, 114688
    s_add_u32 m0, s100, 49152
    s_nop 0
    buffer_load_dwordx4 v8, s[52:55], s81 offen offset:0 lds
    buffer_load_dwordx4 v9, s[52:55], s81 offen offset:1024 lds
    v_mfma_f32_16x16x32_bf16 v[108:111], v[56:59], v[92:95], 0
    buffer_load_dwordx4 v10, s[52:55], s81 offen offset:2048 lds
    v_mfma_f32_16x16x32_bf16 v[108:111], v[56:59], v[96:99], v[108:111]
    buffer_load_dwordx4 v11, s[52:55], s81 offen offset:3072 lds
    s_xor_b32 s81, s93, 4
    s_add_u32 s81, s81, s84
    s_and_b32 s81, s81, 7
    s_mul_i32 s81, s81, s76
    s_add_u32 m0, s98, 81920
    s_nop 0
    buffer_load_dwordx4 v4, s[48:51], s81 offen offset:0 lds
    v_mfma_f32_16x16x32_bf16 v[108:111], v[56:59], v[100:103], v[108:111]
    buffer_load_dwordx4 v5, s[48:51], s81 offen offset:1024 lds
    v_mfma_f32_16x16x32_bf16 v[108:111], v[56:59], v[104:107], v[108:111]
    s_waitcnt vmcnt(14)
    s_waitcnt lgkmcnt(0)
    s_barrier
    s_xor_b32 s81, s93, 4
    s_add_u32 s81, s81, s84
    s_and_b32 s81, s81, 7
    s_mul_i32 s81, s81, 229376
    s_add_u32 m0, s100, 0
    s_nop 0
    buffer_load_dwordx4 v8, s[52:55], s81 offen offset:0 lds
    v_cvt_pk_bf16_f32 v109, v108, v108
    buffer_load_dwordx4 v9, s[52:55], s81 offen offset:1024 lds
    v_and_b32 v109, 0xffff0000, v109
    buffer_load_dwordx4 v10, s[52:55], s81 offen offset:2048 lds
    v_sub_f32 v110, v108, v109
    buffer_load_dwordx4 v11, s[52:55], s81 offen offset:3072 lds
    v_cvt_pk_bf16_f32 v108, v109, v110
    s_xor_b32 s81, s93, 4
    s_add_u32 s81, s81, s84
    s_and_b32 s81, s81, 7
    s_mul_i32 s81, s81, s76
    s_add_u32 m0, s98, 81920
    s_nop 0
    buffer_load_dwordx4 v6, s[48:51], s81 offen offset:2048 lds
    v_mov_b32 v109, s89
    buffer_load_dwordx4 v7, s[48:51], s81 offen offset:3072 lds
    s_mov_b64 exec, 0xffff
    buffer_store_dwordx2 v[108:109], v79, s[72:75], s101 offen sc1
    s_mov_b64 exec, -1
    s_waitcnt vmcnt(15)
    s_waitcnt vmcnt(13)
    s_waitcnt lgkmcnt(0)
    s_barrier
    s_xor_b32 s81, s93, 4
    s_add_u32 s81, s81, s84
    s_and_b32 s81, s81, 7
    s_mul_i32 s81, s81, 229376
    s_add_u32 s81, s81, 114688
    s_add_u32 m0, s100, 16384
    s_nop 0
    buffer_load_dwordx4 v8, s[52:55], s81 offen offset:0 lds
    s_cmp_eq_u32 s9, 7
    s_cselect_b32 s99, 3, s9
    s_mul_i32 s78, s12, 458752
    s_lshl_b32 s13, s9, 7
    s_add_u32 s78, s78, s13
    s_and_b32 s13, s8, 1
    s_lshl_b32 s13, s13, 15
    s_add_u32 s78, s78, s13
    v_lshlrev_b32 v44, 1, v24
    v_xor_b32 v44, v44, v23
    v_lshlrev_b32 v44, 4, v44
    v_lshl_add_u32 v44, v22, 10, v44
    buffer_load_dwordx4 v9, s[52:55], s81 offen offset:1024 lds
    v_add_u32 v45, 7168, v44
    v_add_u32 v46, 14336, v44
    v_add_u32 v47, 21504, v44
    v_and_b32 v78, 1, v0
    v_lshrrev_b32 v87, 1, v0
    buffer_load_dwordx4 v10, s[52:55], s81 offen offset:2048 lds
    v_min_u32 v77, 7, v87
    v_lshlrev_b32 v87, 13, v87
    v_lshl_add_u32 v87, v78, 4, v87
    v_mul_u32_u24 v77, 4160, v77
    v_lshl_add_u32 v77, v78, 4, v77
    buffer_load_dwordx4 v11, s[52:55], s81 offen offset:3072 lds
    v_add_u32 v77, 118784, v77
    s_lshl_b32 s14, s95, 12
    s_lshl_b32 s13, s97, 11
    s_add_u32 s14, s14, s13
    s_xor_b32 s81, s93, 5
    s_add_u32 s81, s81, s84
    s_and_b32 s81, s81, 7
    s_mul_i32 s81, s81, s76
    s_add_u32 m0, s98, 98304
    s_nop 0
    buffer_load_dwordx4 v4, s[48:51], s81 offen offset:0 lds
    s_add_u32 s92, s14, 2097152
    s_mul_i32 s14, s96, 4752
    s_add_u32 s14, s14, 154272
    v_mov_b32 v91, s14
    s_lshl_b32 s14, s12, 10
    buffer_load_dwordx4 v5, s[48:51], s81 offen offset:1024 lds
    s_sub_u32 s15, 4094, s14
    v_sub_u32 v88, s15, v1
    v_cvt_f32_i32 v88, v88
    s_add_u32 s14, s14, 114688
    v_add_u32 v76, s14, v1
    s_waitcnt vmcnt(15)
    s_waitcnt lgkmcnt(0)
    s_barrier
    s_xor_b32 s81, s93, 5
    s_add_u32 s81, s81, s84
    s_and_b32 s81, s81, 7
    s_mul_i32 s81, s81, 229376
    s_add_u32 m0, s100, 32768
    s_nop 0
    buffer_load_dwordx4 v8, s[52:55], s81 offen offset:0 lds
    v_add_f32 v64, 0x80000000, v88
    v_add_f32 v65, 0xc0000000, v88
    v_cvt_pk_bf16_f32 v65, v64, v65
    v_lshlrev_b32 v64, 16, v65
    buffer_load_dwordx4 v9, s[52:55], s81 offen offset:1024 lds
    v_and_b32 v65, 0xffff0000, v65
    v_cvt_i32_f32 v64, v64
    v_cvt_i32_f32 v65, v65
    v_ashrrev_i32 v28, 7, v64
    buffer_load_dwordx4 v10, s[52:55], s81 offen offset:2048 lds
    v_lshl_add_u32 v64, v28, 2, v64
    v_add_u32 v64, 154288, v64
    v_ashrrev_i32 v28, 7, v65
    v_lshl_add_u32 v65, v28, 2, v65
    v_add_u32 v65, 154288, v65
    buffer_load_dwordx4 v11, s[52:55], s81 offen offset:3072 lds
    v_add_f32 v66, 0xc0800000, v88
    v_add_f32 v67, 0xc0c00000, v88
    v_cvt_pk_bf16_f32 v67, v66, v67
    v_lshlrev_b32 v66, 16, v67
    s_xor_b32 s81, s93, 5
    s_add_u32 s81, s81, s84
    s_and_b32 s81, s81, 7
    s_mul_i32 s81, s81, s76
    s_add_u32 m0, s98, 98304
    s_nop 0
    buffer_load_dwordx4 v6, s[48:51], s81 offen offset:2048 lds
    v_and_b32 v67, 0xffff0000, v67
    v_cvt_i32_f32 v66, v66
    v_cvt_i32_f32 v67, v67
    v_ashrrev_i32 v28, 7, v66
    buffer_load_dwordx4 v7, s[48:51], s81 offen offset:3072 lds
    v_lshl_add_u32 v66, v28, 2, v66
    v_add_u32 v66, 154288, v66
    v_ashrrev_i32 v28, 7, v67
    v_lshl_add_u32 v67, v28, 2, v67
    v_add_u32 v67, 154288, v67
    s_waitcnt vmcnt(15)
    s_waitcnt vmcnt(13)
    s_waitcnt lgkmcnt(0)
    s_barrier
    s_xor_b32 s81, s93, 5
    s_add_u32 s81, s81, s84
    s_and_b32 s81, s81, 7
    s_mul_i32 s81, s81, 229376
    s_add_u32 s81, s81, 114688
    s_add_u32 m0, s100, 49152
    s_nop 0
    buffer_load_dwordx4 v8, s[52:55], s81 offen offset:0 lds
    v_add_f32 v68, 0xc1000000, v88
    v_add_f32 v69, 0xc1200000, v88
    v_cvt_pk_bf16_f32 v69, v68, v69
    v_lshlrev_b32 v68, 16, v69
    buffer_load_dwordx4 v9, s[52:55], s81 offen offset:1024 lds
    v_and_b32 v69, 0xffff0000, v69
    v_cvt_i32_f32 v68, v68
    v_cvt_i32_f32 v69, v69
    v_ashrrev_i32 v28, 7, v68
    buffer_load_dwordx4 v10, s[52:55], s81 offen offset:2048 lds
    v_lshl_add_u32 v68, v28, 2, v68
    v_add_u32 v68, 154288, v68
    v_ashrrev_i32 v28, 7, v69
    v_lshl_add_u32 v69, v28, 2, v69
    v_add_u32 v69, 154288, v69
    buffer_load_dwordx4 v11, s[52:55], s81 offen offset:3072 lds
    v_add_f32 v70, 0xc1400000, v88
    v_add_f32 v71, 0xc1600000, v88
    v_cvt_pk_bf16_f32 v71, v70, v71
    v_lshlrev_b32 v70, 16, v71
    s_xor_b32 s81, s93, 6
    s_add_u32 s81, s81, s84
    s_and_b32 s81, s81, 7
    s_mul_i32 s81, s81, s76
    s_add_u32 m0, s98, 65536
    s_nop 0
    buffer_load_dwordx4 v4, s[48:51], s81 offen offset:0 lds
    v_and_b32 v71, 0xffff0000, v71
    v_cvt_i32_f32 v70, v70
    v_cvt_i32_f32 v71, v71
    v_ashrrev_i32 v28, 7, v70
    buffer_load_dwordx4 v5, s[48:51], s81 offen offset:1024 lds
    v_lshl_add_u32 v70, v28, 2, v70
    v_add_u32 v70, 154288, v70
    v_ashrrev_i32 v28, 7, v71
    v_lshl_add_u32 v71, v28, 2, v71
    v_add_u32 v71, 154288, v71
    s_waitcnt vmcnt(14)
    s_waitcnt lgkmcnt(0)
    s_barrier
    s_xor_b32 s81, s93, 6
    s_add_u32 s81, s81, s84
    s_and_b32 s81, s81, 7
    s_mul_i32 s81, s81, 229376
    s_add_u32 m0, s100, 0
    s_nop 0
    buffer_load_dwordx4 v8, s[52:55], s81 offen offset:0 lds
    v_add_f32 v72, 0xc1800000, v88
    v_add_f32 v73, 0xc1900000, v88
    v_cvt_pk_bf16_f32 v73, v72, v73
    v_lshlrev_b32 v72, 16, v73
    buffer_load_dwordx4 v9, s[52:55], s81 offen offset:1024 lds
    v_and_b32 v73, 0xffff0000, v73
    v_cvt_i32_f32 v72, v72
    v_cvt_i32_f32 v73, v73
    v_ashrrev_i32 v28, 7, v72
    buffer_load_dwordx4 v10, s[52:55], s81 offen offset:2048 lds
    v_lshl_add_u32 v72, v28, 2, v72
    v_add_u32 v72, 154288, v72
    v_ashrrev_i32 v28, 7, v73
    v_lshl_add_u32 v73, v28, 2, v73
    v_add_u32 v73, 154288, v73
    buffer_load_dwordx4 v11, s[52:55], s81 offen offset:3072 lds
    v_add_f32 v74, 0xc1a00000, v88
    v_add_f32 v75, 0xc1b00000, v88
    v_cvt_pk_bf16_f32 v75, v74, v75
    v_lshlrev_b32 v74, 16, v75
    s_xor_b32 s81, s93, 6
    s_add_u32 s81, s81, s84
    s_and_b32 s81, s81, 7
    s_mul_i32 s81, s81, s76
    s_add_u32 m0, s98, 65536
    s_nop 0
    buffer_load_dwordx4 v6, s[48:51], s81 offen offset:2048 lds
    v_and_b32 v75, 0xffff0000, v75
    v_cvt_i32_f32 v74, v74
    v_cvt_i32_f32 v75, v75
    v_ashrrev_i32 v28, 7, v74
    buffer_load_dwordx4 v7, s[48:51], s81 offen offset:3072 lds
    v_lshl_add_u32 v74, v28, 2, v74
    v_add_u32 v74, 154288, v74
    v_ashrrev_i32 v28, 7, v75
    v_lshl_add_u32 v75, v28, 2, v75
    v_add_u32 v75, 154288, v75
    s_waitcnt vmcnt(14)
    s_waitcnt vmcnt(12)
    s_waitcnt lgkmcnt(0)
    s_barrier
    s_xor_b32 s81, s93, 6
    s_add_u32 s81, s81, s84
    s_and_b32 s81, s81, 7
    s_mul_i32 s81, s81, 229376
    s_add_u32 s81, s81, 114688
    s_add_u32 m0, s100, 16384
    s_nop 0
    buffer_load_dwordx4 v8, s[52:55], s81 offen offset:0 lds
    v_sub_u32 v28, 3, v27
    v_and_b32 v28, 3, v28
    v_lshl_add_u32 v29, v24, 3, v27
    v_add_u32 v29, v29, v28
    v_sub_u32 v29, 167, v29
    buffer_load_dwordx4 v9, s[52:55], s81 offen offset:1024 lds
    v_lshlrev_b32 v29, 1, v29
    v_mul_u32_u24 v28, 4160, v28
    v_add_u32 v48, v28, v29
    s_mul_i32 s13, s96, 16640
    s_add_u32 s13, s13, 114688
    s_lshl_b32 s15, s97, 8
    buffer_load_dwordx4 v10, s[52:55], s81 offen offset:2048 lds
    s_sub_u32 s14, s13, s15
    v_add_u32 v48, s14, v48
    s_lshl_b32 s15, s97, 11
    s_add_u32 s14, s13, s15
    v_add_u32 v54, s14, v1
    buffer_load_dwordx4 v11, s[52:55], s81 offen offset:3072 lds
    v_lshlrev_b32 v49, 1, v27
    v_sub_u32 v49, v49, v24
    v_lshlrev_b32 v49, 5, v49
    s_lshl_b32 s13, s96, 4
    s_lshl_b32 s15, s97, 9
    s_sub_u32 s14, s13, s15
    s_xor_b32 s81, s93, 7
    s_add_u32 s81, s81, s84
    s_and_b32 s81, s81, 7
    s_mul_i32 s81, s81, s76
    s_add_u32 m0, s98, 81920
    s_nop 0
    buffer_load_dwordx4 v4, s[48:51], s81 offen offset:0 lds
    s_add_u32 s14, s14, 154944
    v_add_u32 v49, s14, v49
    v_lshrrev_b32 v50, 1, v24
    v_lshl_add_u32 v50, v27, 1, v50
    v_lshlrev_b32 v50, 5, v50
    buffer_load_dwordx4 v5, s[48:51], s81 offen offset:1024 lds
    v_and_b32 v28, 1, v24
    v_lshl_add_u32 v50, v28, 3, v50
    s_lshl_b32 s15, s97, 12
    s_add_u32 s14, s13, s15
    s_add_u32 s14, s14, 155296
    v_add_u32 v50, s14, v50
    s_waitcnt vmcnt(14)
    s_waitcnt lgkmcnt(0)
    s_barrier
    s_xor_b32 s81, s93, 7
    s_add_u32 s81, s81, s84
    s_and_b32 s81, s81, 7
    s_mul_i32 s81, s81, 229376
    s_add_u32 m0, s100, 32768
    s_nop 0
    buffer_load_dwordx4 v8, s[52:55], s81 offen offset:0 lds
    s_mul_i32 s14, s96, 16640
    s_add_u32 s14, s14, 118784
    buffer_load_dwordx4 v9, s[52:55], s81 offen offset:1024 lds
    s_lshl_b32 s13, s97, 12
    s_add_u32 s15, s14, s13
    v_add_u32 v51, s15, v1
    buffer_load_dwordx4 v10, s[52:55], s81 offen offset:2048 lds
    s_xor_b32 s13, s13, 4096
    s_add_u32 s15, s14, s13
    v_add_u32 v81, s15, v1
    buffer_load_dwordx4 v11, s[52:55], s81 offen offset:3072 lds
    v_lshlrev_b32 v52, 5, v27
    v_lshl_add_u32 v52, v24, 3, v52
    v_lshlrev_b32 v53, 1, v24
    s_xor_b32 s81, s93, 7
    s_add_u32 s81, s81, s84
    s_and_b32 s81, s81, 7
    s_mul_i32 s81, s81, s76
    s_add_u32 m0, s98, 81920
    s_nop 0
    buffer_load_dwordx4 v6, s[48:51], s81 offen offset:2048 lds
    v_xor_b32 v53, v53, v23
    v_lshlrev_b32 v53, 4, v53
    v_lshl_add_u32 v53, v22, 12, v53
    buffer_load_dwordx4 v7, s[48:51], s81 offen offset:3072 lds
    s_lshl_b32 s14, s12, 11
    s_add_u32 s14, s14, 154272
    v_add_u32 v55, s14, v1
    s_waitcnt vmcnt(14)
    s_waitcnt vmcnt(12)
    s_waitcnt lgkmcnt(0)
    s_barrier
    s_xor_b32 s81, s93, 7
    s_add_u32 s81, s81, s84
    s_and_b32 s81, s81, 7
    s_mul_i32 s81, s81, 229376
    s_add_u32 s81, s81, 114688
    s_add_u32 m0, s100, 49152
    s_nop 0
    buffer_load_dwordx4 v8, s[52:55], s81 offen offset:0 lds
    ds_read_b128 v[132:135], v113 offset:0
    ds_read_b128 v[136:139], v113 offset:8448
    ds_read_b128 v[144:147], v113 offset:64
    buffer_load_dwordx4 v9, s[52:55], s81 offen offset:1024 lds
    ds_read_b128 v[148:151], v113 offset:8512
    ds_read_b128 v[156:159], v113 offset:128
    ds_read_b128 v[160:163], v113 offset:8576
    buffer_load_dwordx4 v10, s[52:55], s81 offen offset:2048 lds
    ds_read_b128 v[168:171], v113 offset:192
    ds_read_b128 v[172:175], v113 offset:8640
    ds_read_b128 v[180:183], v113 offset:256
    buffer_load_dwordx4 v11, s[52:55], s81 offen offset:3072 lds
    ds_read_b128 v[184:187], v113 offset:8704
    ds_read_b128 v[192:195], v113 offset:320
    ds_read_b128 v[196:199], v113 offset:8768
    s_lshl_b32 s81, s99, 16
    s_add_u32 s81, s81, s78
    s_add_u32 m0, s98, 98304
    s_add_u32 s99, s99, 1
    s_cmp_eq_u32 s99, 7
    s_cselect_b32 s99, 0, s99
    buffer_load_dwordx4 v44, s[56:59], s81 offen offset:0 lds
    ds_read_b128 v[204:207], v113 offset:384
    ds_read_b128 v[208:211], v113 offset:8832
    ds_read_b128 v[216:219], v113 offset:448
    buffer_load_dwordx4 v45, s[56:59], s81 offen offset:1024 lds
    ds_read_b128 v[220:223], v113 offset:8896
    v_and_b32 v86, 0x1f0, v1
    s_lshl_b32 s15, s6, 11
    buffer_load_dwordx4 v46, s[56:59], s81 offen offset:2048 lds
    s_lshl_b32 s14, s12, 9
    s_add_u32 s15, s15, s14
    s_add_u32 s15, s15, 11796480
    buffer_load_dwordx4 v47, s[56:59], s81 offen offset:3072 lds
    buffer_load_dwordx4 v[92:95], v79, s[72:75], s94 offen sc1
    buffer_load_dwordx4 v[96:99], v79, s[72:75], s94 offen offset:16 sc1
    buffer_load_dwordx2 v[100:101], v86, s[72:75], s15 offen sc1
    s_waitcnt vmcnt(19)
    s_waitcnt lgkmcnt(0)
    s_barrier
    s_lshl_b32 s81, s99, 16
    s_add_u32 s81, s81, s78
    s_add_u32 m0, s98, 0
    s_add_u32 s99, s99, 1
    s_cmp_eq_u32 s99, 7
    s_cselect_b32 s99, 0, s99
    buffer_load_dwordx4 v44, s[56:59], s81 offen offset:0 lds
    v_mfma_f32_16x16x32_f16 v[120:123], v[128:131], v[132:135], 0
    v_mfma_f32_16x16x32_f16 v[124:127], v[128:131], v[136:139], 0
    v_mfma_f32_16x16x32_f16 v[120:123], v[140:143], v[144:147], v[120:123]
    v_mfma_f32_16x16x32_f16 v[124:127], v[140:143], v[148:151], v[124:127]
    buffer_load_dwordx4 v45, s[56:59], s81 offen offset:1024 lds
    v_mfma_f32_16x16x32_f16 v[120:123], v[152:155], v[156:159], v[120:123]
    v_mfma_f32_16x16x32_f16 v[124:127], v[152:155], v[160:163], v[124:127]
    v_mfma_f32_16x16x32_f16 v[120:123], v[164:167], v[168:171], v[120:123]
    v_mfma_f32_16x16x32_f16 v[124:127], v[164:167], v[172:175], v[124:127]
    v_mfma_f32_16x16x32_f16 v[120:123], v[176:179], v[180:183], v[120:123]
    buffer_load_dwordx4 v46, s[56:59], s81 offen offset:2048 lds
    v_mfma_f32_16x16x32_f16 v[124:127], v[176:179], v[184:187], v[124:127]
    v_mfma_f32_16x16x32_f16 v[120:123], v[188:191], v[192:195], v[120:123]
    v_mfma_f32_16x16x32_f16 v[124:127], v[188:191], v[196:199], v[124:127]
    v_mfma_f32_16x16x32_f16 v[120:123], v[200:203], v[204:207], v[120:123]
    v_mfma_f32_16x16x32_f16 v[124:127], v[200:203], v[208:211], v[124:127]
    buffer_load_dwordx4 v47, s[56:59], s81 offen offset:3072 lds
    v_mfma_f32_16x16x32_f16 v[120:123], v[212:215], v[216:219], v[120:123]
    v_mfma_f32_16x16x32_f16 v[124:127], v[212:215], v[220:223], v[124:127]
    s_lshl_b32 s95, s12, 11
    s_add_u32 s95, s95, 11927552
    buffer_load_dwordx4 v[104:107], v79, s[68:71], s95 offen sc1
    s_waitcnt vmcnt(12)
    s_waitcnt lgkmcnt(0)
    s_barrier
    s_setprio 3
    s_waitcnt vmcnt(5)
    s_cmp_ge_u32 s5, 28
    s_cbranch_scc1 L_pl29
    s_mov_b32 s14, 0
L_cc27:
    v_min3_u32 v102, v93, v95, v97
    v_max3_u32 v103, v93, v95, v97
    v_min3_u32 v102, v102, v99, v101
    v_max3_u32 v103, v103, v99, v101
    v_xor_b32 v102, s89, v102
    v_xor_b32 v103, s89, v103
    v_or_b32 v102, v102, v103
    v_cmp_ne_u32 vcc, 0, v102
    s_cbranch_vccnz L_cq28
L_pl29:
    v_mov_b32 v93, v94
    v_mov_b32 v94, v96
    v_mov_b32 v95, v98
    s_lshl_b32 s14, s12, 10
    s_add_u32 s14, s14, 114688
    v_add_u32 v102, s14, v1
    ds_write_b128 v102, v[92:95]
    s_lshl_b32 s14, s12, 7
    s_add_u32 s14, s14, 118784
    v_lshrrev_b32 v103, 2, v86
    v_add_u32 v103, s14, v103
    ds_write_b32 v103, v100
    v_mov_b32 v19, 1
    s_mov_b64 exec, 1
    ds_write_b32 v16, v19
    s_mov_b64 exec, -1
    s_setprio 0
    s_lshl_b32 s81, s99, 16
    s_add_u32 s81, s81, s78
    s_add_u32 m0, s98, 16384
    s_add_u32 s99, s99, 1
    s_cmp_eq_u32 s99, 7
    s_cselect_b32 s99, 0, s99
    buffer_load_dwordx4 v44, s[56:59], s81 offen offset:0 lds
    buffer_load_dwordx4 v45, s[56:59], s81 offen offset:1024 lds
    buffer_load_dwordx4 v46, s[56:59], s81 offen offset:2048 lds
    buffer_load_dwordx4 v47, s[56:59], s81 offen offset:3072 lds
    s_lshl_b32 s81, s99, 16
    s_add_u32 s81, s81, s78
    s_add_u32 m0, s98, 65536
    s_add_u32 s99, s99, 1
    s_cmp_eq_u32 s99, 7
    s_cselect_b32 s99, 0, s99
    buffer_load_dwordx4 v44, s[56:59], s81 offen offset:0 lds
    buffer_load_dwordx4 v45, s[56:59], s81 offen offset:1024 lds
    buffer_load_dwordx4 v46, s[56:59], s81 offen offset:2048 lds
    buffer_load_dwordx4 v47, s[56:59], s81 offen offset:3072 lds
    s_setprio 0
    v_xor_b32 v20, 8, v16
    v_mov_b32 v7, v81
    s_lshl_b32 s14, s96, 2
    s_add_u32 s14, s14, 163824
    v_mov_b32 v9, s14
    ds_read_b32 v21, v9
    s_lshl_b32 s15, s96, 1
    s_add_u32 s15, s15, s97
    s_lshl_b32 s14, s9, 2
    s_add_u32 s14, s14, s15
    s_lshl_b32 s86, s14, 16
    s_lshl_b32 s87, s8, 7
    s_add_u32 s86, s86, s87
    s_add_u32 s86, s86, 2097152
    s_add_u32 s87, s86, 32768
    v_cvt_f16_f32 v120, v120
    ds_write_b16 v114, v120 offset:0
    v_cvt_f16_f32 v121, v121
    ds_write_b16 v115, v121 offset:0
    v_cvt_f16_f32 v122, v122
    ds_write_b16 v116, v122 offset:0
    v_cvt_f16_f32 v123, v123
    ds_write_b16 v117, v123 offset:0
    v_cvt_f16_f32 v124, v124
    ds_write_b16 v114, v124 offset:264
    v_cvt_f16_f32 v125, v125
    ds_write_b16 v115, v125 offset:264
    v_cvt_f16_f32 v126, v126
    ds_write_b16 v116, v126 offset:264
    v_cvt_f16_f32 v127, v127
    ds_write_b16 v117, v127 offset:264
    s_mov_b64 exec, 1
    ds_write_b128 v91, v[60:63]
    s_mov_b64 exec, -1
    v_mov_b32 v19, 2
    s_mov_b64 exec, 1
    ds_write_b32 v16, v19
    s_mov_b64 exec, -1
    s_waitcnt vmcnt(8)
    v_min3_u32 v102, v104, v105, v106
    v_max3_u32 v103, v104, v105, v106
    v_min_u32 v102, v102, v107
    v_max_u32 v103, v103, v107
    v_xor_b32 v102, s89, v102
    v_xor_b32 v103, s89, v103
    v_or_b32 v102, v102, v103
    v_cmp_ne_u32 vcc, 0, v102
    s_cbranch_vccnz L_ps30
L_pl31:
    s_lshl_b32 s14, s12, 19
    s_lshl_b32 s13, s10, 5
    s_add_u32 s14, s14, s13
    s_add_u32 s13, s14, 262144
    buffer_load_dwordx4 v[104:107], v87, s[68:71], s14 offen sc1
    buffer_load_dwordx4 v[108:111], v87, s[68:71], s13 offen sc1
    v_add_u32 v8, 154272, v1
    s_mov_b32 s15, 0
L_s33:
    ds_read_b32 v19, v17 offset:16
    s_waitcnt lgkmcnt(0)
    v_cmp_gt_u32 vcc, 2, v19
    s_cbranch_vccz L_sd34
    s_add_u32 s15, s15, 1
    s_cmp_lt_u32 s15, 0x40000
    s_cbranch_scc1 L_s33
L_sd34:
    ds_read_u16 v128, v64 offset:0
    ds_read_u16 v129, v65 offset:0
    ds_read_u16 v130, v66 offset:0
    ds_read_u16 v131, v67 offset:0
    ds_read_u16 v132, v68 offset:0
    ds_read_u16 v133, v69 offset:0
    ds_read_u16 v134, v70 offset:0
    ds_read_u16 v135, v71 offset:0
    ds_read_u16 v136, v72 offset:0
    ds_read_u16 v137, v73 offset:0
    ds_read_u16 v138, v74 offset:0
    ds_read_u16 v140, v64 offset:4752
    ds_read_u16 v141, v65 offset:4752
    ds_read_u16 v142, v66 offset:4752
    ds_read_u16 v143, v67 offset:4752
    ds_read_u16 v144, v68 offset:4752
    ds_read_u16 v145, v69 offset:4752
    ds_read_u16 v146, v70 offset:4752
    ds_read_u16 v147, v71 offset:4752
    ds_read_u16 v148, v72 offset:4752
    ds_read_u16 v149, v73 offset:4752
    ds_read_u16 v150, v74 offset:4752
    s_mov_b32 s15, 0
L_s35:
    ds_read_b32 v19, v17 offset:0
    s_waitcnt lgkmcnt(0)
    v_cmp_gt_u32 vcc, 1, v19
    s_cbranch_vccz L_sd36
    s_add_u32 s15, s15, 1
    s_cmp_lt_u32 s15, 0x40000
    s_cbranch_scc1 L_s35
L_sd36:
    v_mov_b32 v19, 3
    s_mov_b64 exec, 1
    ds_write_b32 v16, v19
    s_mov_b64 exec, -1
    s_lshl_b32 s81, s99, 16
    s_add_u32 s81, s81, s78
    s_add_u32 m0, s98, 81920
    s_add_u32 s99, s99, 1
    s_cmp_eq_u32 s99, 7
    s_cselect_b32 s99, 0, s99
    buffer_load_dwordx4 v44, s[56:59], s81 offen offset:0 lds
    buffer_load_dwordx4 v45, s[56:59], s81 offen offset:1024 lds
    buffer_load_dwordx4 v46, s[56:59], s81 offen offset:2048 lds
    buffer_load_dwordx4 v47, s[56:59], s81 offen offset:3072 lds
    v_lshl_or_b32 v152, v129, 16, v128
    v_lshl_or_b32 v153, v131, 16, v130
    v_lshl_or_b32 v154, v133, 16, v132
    v_lshl_or_b32 v155, v135, 16, v134
    ds_write_b128 v76, v[152:155] offset:0
    v_lshl_or_b32 v156, v130, 16, v129
    v_lshl_or_b32 v157, v132, 16, v131
    v_lshl_or_b32 v158, v134, 16, v133
    v_lshl_or_b32 v159, v136, 16, v135
    ds_write_b128 v76, v[156:159] offset:4160
    v_lshl_or_b32 v160, v131, 16, v130
    v_lshl_or_b32 v161, v133, 16, v132
    v_lshl_or_b32 v162, v135, 16, v134
    v_lshl_or_b32 v163, v137, 16, v136
    ds_write_b128 v76, v[160:163] offset:8320
    v_lshl_or_b32 v164, v132, 16, v131
    v_lshl_or_b32 v165, v134, 16, v133
    v_lshl_or_b32 v166, v136, 16, v135
    v_lshl_or_b32 v167, v138, 16, v137
    ds_write_b128 v76, v[164:167] offset:12480
    v_lshl_or_b32 v168, v141, 16, v140
    v_lshl_or_b32 v169, v143, 16, v142
    v_lshl_or_b32 v170, v145, 16, v144
    v_lshl_or_b32 v171, v147, 16, v146
    ds_write_b128 v76, v[168:171] offset:16640
    v_lshl_or_b32 v172, v142, 16, v141
    v_lshl_or_b32 v173, v144, 16, v143
    v_lshl_or_b32 v174, v146, 16, v145
    v_lshl_or_b32 v175, v148, 16, v147
    ds_write_b128 v76, v[172:175] offset:20800
    v_lshl_or_b32 v176, v143, 16, v142
    v_lshl_or_b32 v177, v145, 16, v144
    v_lshl_or_b32 v178, v147, 16, v146
    v_lshl_or_b32 v179, v149, 16, v148
    ds_write_b128 v76, v[176:179] offset:24960
    v_lshl_or_b32 v180, v144, 16, v143
    v_lshl_or_b32 v181, v146, 16, v145
    v_lshl_or_b32 v182, v148, 16, v147
    v_lshl_or_b32 v183, v150, 16, v149
    ds_write_b128 v76, v[180:183] offset:29120
    ds_write_b128 v77, v[60:63]
    s_waitcnt vmcnt(0)
    v_mov_b32 v19, 4
    s_mov_b64 exec, 1
    ds_write_b32 v16, v19
    s_mov_b64 exec, -1
    s_mov_b32 s15, 0
L_s37:
    ds_read_b32 v19, v17 offset:16
    s_waitcnt lgkmcnt(0)
    v_cmp_gt_u32 vcc, 3, v19
    s_cbranch_vccz L_sd38
    s_add_u32 s15, s15, 1
    s_cmp_lt_u32 s15, 0x40000
    s_cbranch_scc1 L_s37
L_sd38:
    ds_write_b128 v55, v[104:107] offset:1024
    ds_write_b128 v55, v[108:111] offset:2048
    ds_write_b128 v8, v[60:63]
    v_mov_b32 v19, 5
    s_mov_b64 exec, 1
    ds_write_b32 v16, v19
    s_mov_b64 exec, -1
    s_mov_b32 s15, 0
L_s39:
    ds_read_b32 v19, v17 offset:16
    s_waitcnt lgkmcnt(0)
    v_cmp_gt_u32 vcc, 5, v19
    s_cbranch_vccz L_sd40
    s_add_u32 s15, s15, 1
    s_cmp_lt_u32 s15, 0x40000
    s_cbranch_scc1 L_s39
L_sd40:
    ds_read_b64 v[32:33], v50 offset:0
    ds_read_b64 v[34:35], v50 offset:1024
    ds_read_b64 v[36:37], v50 offset:2048
    ds_read_b64 v[38:39], v50 offset:3072
    ds_read_b128 v[96:99], v49 offset:384
    ds_read_b64 v[64:65], v48 offset:3776
    ds_read_b64 v[66:67], v48 offset:3784
    ds_read_b128 v[100:103], v49 offset:1408
    ds_read_b64 v[68:69], v48 offset:3264
    ds_read_b64 v[70:71], v48 offset:3272
    ds_read_b128 v[104:107], v49 offset:2432
    ds_read_b64 v[72:73], v48 offset:2752
    ds_read_b64 v[74:75], v48 offset:2760
    ds_read_b128 v[108:111], v49 offset:3456
    ds_read_b64 v[76:77], v48 offset:2240
    ds_read_b64 v[78:79], v48 offset:2248
    ds_read_b128 v[112:115], v49 offset:4480
    ds_read_b64 v[80:81], v48 offset:1728
    ds_read_b64 v[82:83], v48 offset:1736
    ds_read_b128 v[116:119], v49 offset:5504
    ds_read_b64 v[84:85], v48 offset:1216
    ds_read_b64 v[86:87], v48 offset:1224
    ds_read_b128 v[120:123], v49 offset:6528
    ds_read_b64 v[88:89], v48 offset:704
    ds_read_b64 v[90:91], v48 offset:712
    ds_read_b128 v[124:127], v49 offset:7552
    ds_read_b64 v[92:93], v48 offset:192
    ds_read_b64 v[94:95], v48 offset:200
    s_setprio 0
    s_mov_b32 s15, 0
L_s41:
    ds_read_b32 v19, v17 offset:0
    s_waitcnt lgkmcnt(0)
    v_cmp_gt_u32 vcc, 3, v19
    s_cbranch_vccz L_sd42
    s_sleep 1
    s_add_u32 s15, s15, 1
    s_cmp_lt_u32 s15, 0x40000
    s_cbranch_scc1 L_s41
L_sd42:
    s_setprio 1
    v_mfma_f32_16x16x32_f16 v[192:195], v[64:67], v[96:99], 0
    ds_read_b128 v[160:163], v49 offset:256
    v_mfma_f32_16x16x32_f16 v[196:199], v[64:67], v[100:103], 0
    ds_read_b64 v[128:129], v48 offset:3712
    v_mfma_f32_16x16x32_f16 v[200:203], v[64:67], v[104:107], 0
    ds_read_b64 v[130:131], v48 offset:3720
    v_mfma_f32_16x16x32_f16 v[204:207], v[64:67], v[108:111], 0
    ds_read_b128 v[164:167], v49 offset:1280
    v_mfma_f32_16x16x32_f16 v[208:211], v[64:67], v[112:115], 0
    ds_read_b64 v[132:133], v48 offset:3200
    v_mfma_f32_16x16x32_f16 v[212:215], v[64:67], v[116:119], 0
    ds_read_b64 v[134:135], v48 offset:3208
    v_mfma_f32_16x16x32_f16 v[216:219], v[64:67], v[120:123], 0
    ds_read_b128 v[168:171], v49 offset:2304
    v_mfma_f32_16x16x32_f16 v[220:223], v[64:67], v[124:127], 0
    ds_read_b64 v[136:137], v48 offset:2688
    v_mfma_f32_16x16x32_f16 v[196:199], v[68:71], v[96:99], v[196:199]
    ds_read_b64 v[138:139], v48 offset:2696
    v_mfma_f32_16x16x32_f16 v[200:203], v[68:71], v[100:103], v[200:203]
    ds_read_b128 v[172:175], v49 offset:3328
    v_mfma_f32_16x16x32_f16 v[204:207], v[68:71], v[104:107], v[204:207]
    ds_read_b64 v[140:141], v48 offset:2176
    v_mfma_f32_16x16x32_f16 v[208:211], v[68:71], v[108:111], v[208:211]
    ds_read_b64 v[142:143], v48 offset:2184
    v_mfma_f32_16x16x32_f16 v[212:215], v[68:71], v[112:115], v[212:215]
    ds_read_b128 v[176:179], v49 offset:4352
    v_mfma_f32_16x16x32_f16 v[216:219], v[68:71], v[116:119], v[216:219]
    ds_read_b64 v[144:145], v48 offset:1664
    v_mfma_f32_16x16x32_f16 v[220:223], v[68:71], v[120:123], v[220:223]
    ds_read_b64 v[146:147], v48 offset:1672
    v_mfma_f32_16x16x32_f16 v[200:203], v[72:75], v[96:99], v[200:203]
    ds_read_b128 v[180:183], v49 offset:5376
    v_mfma_f32_16x16x32_f16 v[204:207], v[72:75], v[100:103], v[204:207]
    ds_read_b64 v[148:149], v48 offset:1152
    v_mfma_f32_16x16x32_f16 v[208:211], v[72:75], v[104:107], v[208:211]
    ds_read_b64 v[150:151], v48 offset:1160
    v_mfma_f32_16x16x32_f16 v[212:215], v[72:75], v[108:111], v[212:215]
    ds_read_b128 v[184:187], v49 offset:6400
    v_mfma_f32_16x16x32_f16 v[216:219], v[72:75], v[112:115], v[216:219]
    ds_read_b64 v[152:153], v48 offset:640
    v_mfma_f32_16x16x32_f16 v[220:223], v[72:75], v[116:119], v[220:223]
    ds_read_b64 v[154:155], v48 offset:648
    v_mfma_f32_16x16x32_f16 v[204:207], v[76:79], v[96:99], v[204:207]
    ds_read_b128 v[188:191], v49 offset:7424
    v_mfma_f32_16x16x32_f16 v[208:211], v[76:79], v[100:103], v[208:211]
    ds_read_b64 v[156:157], v48 offset:128
    v_mfma_f32_16x16x32_f16 v[212:215], v[76:79], v[104:107], v[212:215]
    ds_read_b64 v[158:159], v48 offset:136
    v_mfma_f32_16x16x32_f16 v[216:219], v[76:79], v[108:111], v[216:219]
    v_cvt_f32_f16 v224, v32
    v_mfma_f32_16x16x32_f16 v[220:223], v[76:79], v[112:115], v[220:223]
    v_cvt_f32_f16_sdwa v225, v32 dst_sel:DWORD dst_unused:UNUSED_PAD src0_sel:WORD_1
    v_mfma_f32_16x16x32_f16 v[208:211], v[80:83], v[96:99], v[208:211]
    v_mul_f32 v224, s77, v224
    v_mfma_f32_16x16x32_f16 v[212:215], v[80:83], v[100:103], v[212:215]
    v_mul_f32 v225, s77, v225
    v_mfma_f32_16x16x32_f16 v[216:219], v[80:83], v[104:107], v[216:219]
    v_cvt_pk_bf16_f32 v225, v224, v225
    v_mfma_f32_16x16x32_f16 v[220:223], v[80:83], v[108:111], v[220:223]
    v_lshlrev_b32 v224, 16, v225
    v_mfma_f32_16x16x32_f16 v[212:215], v[84:87], v[96:99], v[212:215]
    v_and_b32 v225, 0xffff0000, v225
    v_mfma_f32_16x16x32_f16 v[216:219], v[84:87], v[100:103], v[216:219]
    v_cvt_f32_f16 v226, v33
    v_mfma_f32_16x16x32_f16 v[220:223], v[84:87], v[104:107], v[220:223]
    v_mfma_f32_16x16x32_f16 v[216:219], v[88:91], v[96:99], v[216:219]
    v_mfma_f32_16x16x32_f16 v[220:223], v[88:91], v[100:103], v[220:223]
    v_mfma_f32_16x16x32_f16 v[220:223], v[92:95], v[96:99], v[220:223]
    s_waitcnt lgkmcnt(0)
    v_mfma_f32_16x16x32_f16 v[192:195], v[128:131], v[160:163], v[192:195]
    ds_read_b128 v[96:99], v49 offset:128
    v_mfma_f32_16x16x32_f16 v[196:199], v[128:131], v[164:167], v[196:199]
    ds_read_b64 v[64:65], v48 offset:3648
    v_mfma_f32_16x16x32_f16 v[200:203], v[128:131], v[168:171], v[200:203]
    ds_read_b64 v[66:67], v48 offset:3656
    v_mfma_f32_16x16x32_f16 v[204:207], v[128:131], v[172:175], v[204:207]
    ds_read_b128 v[100:103], v49 offset:1152
    v_mfma_f32_16x16x32_f16 v[208:211], v[128:131], v[176:179], v[208:211]
    ds_read_b64 v[68:69], v48 offset:3136
    v_mfma_f32_16x16x32_f16 v[212:215], v[128:131], v[180:183], v[212:215]
    ds_read_b64 v[70:71], v48 offset:3144
    v_mfma_f32_16x16x32_f16 v[216:219], v[128:131], v[184:187], v[216:219]
    ds_read_b128 v[104:107], v49 offset:2176
    v_mfma_f32_16x16x32_f16 v[220:223], v[128:131], v[188:191], v[220:223]
    ds_read_b64 v[72:73], v48 offset:2624
    v_mfma_f32_16x16x32_f16 v[196:199], v[132:135], v[160:163], v[196:199]
    ds_read_b64 v[74:75], v48 offset:2632
    v_mfma_f32_16x16x32_f16 v[200:203], v[132:135], v[164:167], v[200:203]
    ds_read_b128 v[108:111], v49 offset:3200
    v_mfma_f32_16x16x32_f16 v[204:207], v[132:135], v[168:171], v[204:207]
    ds_read_b64 v[76:77], v48 offset:2112
    v_mfma_f32_16x16x32_f16 v[208:211], v[132:135], v[172:175], v[208:211]
    ds_read_b64 v[78:79], v48 offset:2120
    v_mfma_f32_16x16x32_f16 v[212:215], v[132:135], v[176:179], v[212:215]
    ds_read_b128 v[112:115], v49 offset:4224
    v_mfma_f32_16x16x32_f16 v[216:219], v[132:135], v[180:183], v[216:219]
    ds_read_b64 v[80:81], v48 offset:1600
    v_mfma_f32_16x16x32_f16 v[220:223], v[132:135], v[184:187], v[220:223]
    ds_read_b64 v[82:83], v48 offset:1608
    v_mfma_f32_16x16x32_f16 v[200:203], v[136:139], v[160:163], v[200:203]
    ds_read_b128 v[116:119], v49 offset:5248
    v_mfma_f32_16x16x32_f16 v[204:207], v[136:139], v[164:167], v[204:207]
    ds_read_b64 v[84:85], v48 offset:1088
    v_mfma_f32_16x16x32_f16 v[208:211], v[136:139], v[168:171], v[208:211]
    ds_read_b64 v[86:87], v48 offset:1096
    v_mfma_f32_16x16x32_f16 v[212:215], v[136:139], v[172:175], v[212:215]
    ds_read_b128 v[120:123], v49 offset:6272
    v_mfma_f32_16x16x32_f16 v[216:219], v[136:139], v[176:179], v[216:219]
    ds_read_b64 v[88:89], v48 offset:576
    v_mfma_f32_16x16x32_f16 v[220:223], v[136:139], v[180:183], v[220:223]
    ds_read_b64 v[90:91], v48 offset:584
    v_mfma_f32_16x16x32_f16 v[204:207], v[140:143], v[160:163], v[204:207]
    ds_read_b128 v[124:127], v49 offset:7296
    v_mfma_f32_16x16x32_f16 v[208:211], v[140:143], v[164:167], v[208:211]
    ds_read_b64 v[92:93], v48 offset:64
    v_mfma_f32_16x16x32_f16 v[212:215], v[140:143], v[168:171], v[212:215]
    ds_read_b64 v[94:95], v48 offset:72
    v_mfma_f32_16x16x32_f16 v[216:219], v[140:143], v[172:175], v[216:219]
    v_cvt_f32_f16_sdwa v227, v33 dst_sel:DWORD dst_unused:UNUSED_PAD src0_sel:WORD_1
    v_mfma_f32_16x16x32_f16 v[220:223], v[140:143], v[176:179], v[220:223]
    v_mul_f32 v226, s77, v226
    v_mfma_f32_16x16x32_f16 v[208:211], v[144:147], v[160:163], v[208:211]
    v_mul_f32 v227, s77, v227
    v_mfma_f32_16x16x32_f16 v[212:215], v[144:147], v[164:167], v[212:215]
    v_cvt_pk_bf16_f32 v227, v226, v227
    v_mfma_f32_16x16x32_f16 v[216:219], v[144:147], v[168:171], v[216:219]
    v_lshlrev_b32 v226, 16, v227
    v_mfma_f32_16x16x32_f16 v[220:223], v[144:147], v[172:175], v[220:223]
    v_and_b32 v227, 0xffff0000, v227
    v_mfma_f32_16x16x32_f16 v[212:215], v[148:151], v[160:163], v[212:215]
    v_cvt_f32_f16 v228, v34
    v_mfma_f32_16x16x32_f16 v[216:219], v[148:151], v[164:167], v[216:219]
    v_cvt_f32_f16_sdwa v229, v34 dst_sel:DWORD dst_unused:UNUSED_PAD src0_sel:WORD_1
    v_mfma_f32_16x16x32_f16 v[220:223], v[148:151], v[168:171], v[220:223]
    v_mfma_f32_16x16x32_f16 v[216:219], v[152:155], v[160:163], v[216:219]
    v_mfma_f32_16x16x32_f16 v[220:223], v[152:155], v[164:167], v[220:223]
    v_mfma_f32_16x16x32_f16 v[220:223], v[156:159], v[160:163], v[220:223]
    s_waitcnt lgkmcnt(0)
    v_mfma_f32_16x16x32_f16 v[192:195], v[64:67], v[96:99], v[192:195]
    ds_read_b128 v[160:163], v49 offset:0
    v_mfma_f32_16x16x32_f16 v[196:199], v[64:67], v[100:103], v[196:199]
    ds_read_b64 v[128:129], v48 offset:3584
    v_mfma_f32_16x16x32_f16 v[200:203], v[64:67], v[104:107], v[200:203]
    ds_read_b64 v[130:131], v48 offset:3592
    v_mfma_f32_16x16x32_f16 v[204:207], v[64:67], v[108:111], v[204:207]
    ds_read_b128 v[164:167], v49 offset:1024
    v_mfma_f32_16x16x32_f16 v[208:211], v[64:67], v[112:115], v[208:211]
    ds_read_b64 v[132:133], v48 offset:3072
    v_mfma_f32_16x16x32_f16 v[212:215], v[64:67], v[116:119], v[212:215]
    ds_read_b64 v[134:135], v48 offset:3080
    v_mfma_f32_16x16x32_f16 v[216:219], v[64:67], v[120:123], v[216:219]
    ds_read_b128 v[168:171], v49 offset:2048
    v_mfma_f32_16x16x32_f16 v[220:223], v[64:67], v[124:127], v[220:223]
    ds_read_b64 v[136:137], v48 offset:2560
    v_mfma_f32_16x16x32_f16 v[196:199], v[68:71], v[96:99], v[196:199]
    ds_read_b64 v[138:139], v48 offset:2568
    v_mfma_f32_16x16x32_f16 v[200:203], v[68:71], v[100:103], v[200:203]
    ds_read_b128 v[172:175], v49 offset:3072
    v_mfma_f32_16x16x32_f16 v[204:207], v[68:71], v[104:107], v[204:207]
    ds_read_b64 v[140:141], v48 offset:2048
    v_mfma_f32_16x16x32_f16 v[208:211], v[68:71], v[108:111], v[208:211]
    ds_read_b64 v[142:143], v48 offset:2056
    v_mfma_f32_16x16x32_f16 v[212:215], v[68:71], v[112:115], v[212:215]
    ds_read_b128 v[176:179], v49 offset:4096
    v_mfma_f32_16x16x32_f16 v[216:219], v[68:71], v[116:119], v[216:219]
    ds_read_b64 v[144:145], v48 offset:1536
    v_mfma_f32_16x16x32_f16 v[220:223], v[68:71], v[120:123], v[220:223]
    ds_read_b64 v[146:147], v48 offset:1544
    v_mfma_f32_16x16x32_f16 v[200:203], v[72:75], v[96:99], v[200:203]
    ds_read_b128 v[180:183], v49 offset:5120
    v_mfma_f32_16x16x32_f16 v[204:207], v[72:75], v[100:103], v[204:207]
    ds_read_b64 v[148:149], v48 offset:1024
    v_mfma_f32_16x16x32_f16 v[208:211], v[72:75], v[104:107], v[208:211]
    ds_read_b64 v[150:151], v48 offset:1032
    v_mfma_f32_16x16x32_f16 v[212:215], v[72:75], v[108:111], v[212:215]
    ds_read_b128 v[184:187], v49 offset:6144
    v_mfma_f32_16x16x32_f16 v[216:219], v[72:75], v[112:115], v[216:219]
    ds_read_b64 v[152:153], v48 offset:512
    v_mfma_f32_16x16x32_f16 v[220:223], v[72:75], v[116:119], v[220:223]
    ds_read_b64 v[154:155], v48 offset:520
    v_mfma_f32_16x16x32_f16 v[204:207], v[76:79], v[96:99], v[204:207]
    ds_read_b128 v[188:191], v49 offset:7168
    v_mfma_f32_16x16x32_f16 v[208:211], v[76:79], v[100:103], v[208:211]
    ds_read_b64 v[156:157], v48 offset:0
    v_mfma_f32_16x16x32_f16 v[212:215], v[76:79], v[104:107], v[212:215]
    ds_read_b64 v[158:159], v48 offset:8
    v_mfma_f32_16x16x32_f16 v[216:219], v[76:79], v[108:111], v[216:219]
    v_mul_f32 v228, s77, v228
    v_mfma_f32_16x16x32_f16 v[220:223], v[76:79], v[112:115], v[220:223]
    v_mul_f32 v229, s77, v229
    v_mfma_f32_16x16x32_f16 v[208:211], v[80:83], v[96:99], v[208:211]
    v_cvt_pk_bf16_f32 v229, v228, v229
    v_mfma_f32_16x16x32_f16 v[212:215], v[80:83], v[100:103], v[212:215]
    v_lshlrev_b32 v228, 16, v229
    v_mfma_f32_16x16x32_f16 v[216:219], v[80:83], v[104:107], v[216:219]
    v_and_b32 v229, 0xffff0000, v229
    v_mfma_f32_16x16x32_f16 v[220:223], v[80:83], v[108:111], v[220:223]
    v_cvt_f32_f16 v230, v35
    v_mfma_f32_16x16x32_f16 v[212:215], v[84:87], v[96:99], v[212:215]
    v_cvt_f32_f16_sdwa v231, v35 dst_sel:DWORD dst_unused:UNUSED_PAD src0_sel:WORD_1
    v_mfma_f32_16x16x32_f16 v[216:219], v[84:87], v[100:103], v[216:219]
    v_mul_f32 v230, s77, v230
    v_mfma_f32_16x16x32_f16 v[220:223], v[84:87], v[104:107], v[220:223]
    v_mfma_f32_16x16x32_f16 v[216:219], v[88:91], v[96:99], v[216:219]
    v_mfma_f32_16x16x32_f16 v[220:223], v[88:91], v[100:103], v[220:223]
    v_mfma_f32_16x16x32_f16 v[220:223], v[92:95], v[96:99], v[220:223]
    s_waitcnt lgkmcnt(0)
    v_mfma_f32_16x16x32_f16 v[192:195], v[128:131], v[160:163], v[192:195]
    v_mov_b32 v19, 6
    s_mov_b64 exec, 1
    ds_write_b32 v16, v19
    s_mov_b64 exec, -1
    v_mfma_f32_16x16x32_f16 v[196:199], v[128:131], v[164:167], v[196:199]
    v_mul_f32 v231, s77, v231
    v_mfma_f32_16x16x32_f16 v[200:203], v[128:131], v[168:171], v[200:203]
    v_cvt_pk_bf16_f32 v231, v230, v231
    v_mfma_f32_16x16x32_f16 v[204:207], v[128:131], v[172:175], v[204:207]
    v_lshlrev_b32 v230, 16, v231
    v_mfma_f32_16x16x32_f16 v[208:211], v[128:131], v[176:179], v[208:211]
    v_and_b32 v231, 0xffff0000, v231
    v_mfma_f32_16x16x32_f16 v[212:215], v[128:131], v[180:183], v[212:215]
    v_cvt_f32_f16 v232, v36
    v_mfma_f32_16x16x32_f16 v[216:219], v[128:131], v[184:187], v[216:219]
    v_cvt_f32_f16_sdwa v233, v36 dst_sel:DWORD dst_unused:UNUSED_PAD src0_sel:WORD_1
    v_mfma_f32_16x16x32_f16 v[220:223], v[128:131], v[188:191], v[220:223]
    v_mul_f32 v232, s77, v232
    v_mfma_f32_16x16x32_f16 v[196:199], v[132:135], v[160:163], v[196:199]
    v_mul_f32 v233, s77, v233
    v_mfma_f32_16x16x32_f16 v[200:203], v[132:135], v[164:167], v[200:203]
    v_cvt_pk_bf16_f32 v233, v232, v233
    v_mfma_f32_16x16x32_f16 v[204:207], v[132:135], v[168:171], v[204:207]
    v_lshlrev_b32 v232, 16, v233
    v_mfma_f32_16x16x32_f16 v[208:211], v[132:135], v[172:175], v[208:211]
    v_and_b32 v233, 0xffff0000, v233
    v_mfma_f32_16x16x32_f16 v[212:215], v[132:135], v[176:179], v[212:215]
    v_cvt_f32_f16 v234, v37
    v_mfma_f32_16x16x32_f16 v[216:219], v[132:135], v[180:183], v[216:219]
    v_cvt_f32_f16_sdwa v235, v37 dst_sel:DWORD dst_unused:UNUSED_PAD src0_sel:WORD_1
    v_mfma_f32_16x16x32_f16 v[220:223], v[132:135], v[184:187], v[220:223]
    v_mul_f32 v234, s77, v234
    v_mfma_f32_16x16x32_f16 v[200:203], v[136:139], v[160:163], v[200:203]
    v_mul_f32 v235, s77, v235
    v_mfma_f32_16x16x32_f16 v[204:207], v[136:139], v[164:167], v[204:207]
    v_cvt_pk_bf16_f32 v235, v234, v235
    v_mfma_f32_16x16x32_f16 v[208:211], v[136:139], v[168:171], v[208:211]
    v_lshlrev_b32 v234, 16, v235
    v_mfma_f32_16x16x32_f16 v[212:215], v[136:139], v[172:175], v[212:215]
    v_and_b32 v235, 0xffff0000, v235
    v_mfma_f32_16x16x32_f16 v[216:219], v[136:139], v[176:179], v[216:219]
    v_cvt_f32_f16 v236, v38
    v_mfma_f32_16x16x32_f16 v[220:223], v[136:139], v[180:183], v[220:223]
    v_cvt_f32_f16_sdwa v237, v38 dst_sel:DWORD dst_unused:UNUSED_PAD src0_sel:WORD_1
    v_mfma_f32_16x16x32_f16 v[204:207], v[140:143], v[160:163], v[204:207]
    v_mul_f32 v236, s77, v236
    v_mfma_f32_16x16x32_f16 v[208:211], v[140:143], v[164:167], v[208:211]
    v_mul_f32 v237, s77, v237
    v_mfma_f32_16x16x32_f16 v[212:215], v[140:143], v[168:171], v[212:215]
    v_cvt_pk_bf16_f32 v237, v236, v237
    v_mfma_f32_16x16x32_f16 v[216:219], v[140:143], v[172:175], v[216:219]
    v_lshlrev_b32 v236, 16, v237
    v_mfma_f32_16x16x32_f16 v[220:223], v[140:143], v[176:179], v[220:223]
    v_and_b32 v237, 0xffff0000, v237
    v_mfma_f32_16x16x32_f16 v[208:211], v[144:147], v[160:163], v[208:211]
    v_cvt_f32_f16 v238, v39
    v_mfma_f32_16x16x32_f16 v[212:215], v[144:147], v[164:167], v[212:215]
    v_cvt_f32_f16_sdwa v239, v39 dst_sel:DWORD dst_unused:UNUSED_PAD src0_sel:WORD_1
    v_mfma_f32_16x16x32_f16 v[216:219], v[144:147], v[168:171], v[216:219]
    v_mul_f32 v238, s77, v238
    v_mfma_f32_16x16x32_f16 v[220:223], v[144:147], v[172:175], v[220:223]
    v_mul_f32 v239, s77, v239
    v_mfma_f32_16x16x32_f16 v[212:215], v[148:151], v[160:163], v[212:215]
    v_cvt_pk_bf16_f32 v239, v238, v239
    v_mfma_f32_16x16x32_f16 v[216:219], v[148:151], v[164:167], v[216:219]
    v_lshlrev_b32 v238, 16, v239
    v_mfma_f32_16x16x32_f16 v[220:223], v[148:151], v[168:171], v[220:223]
    v_and_b32 v239, 0xffff0000, v239
    v_mfma_f32_16x16x32_f16 v[216:219], v[152:155], v[160:163], v[216:219]
    ds_read_b32 v19, v20
    v_mfma_f32_16x16x32_f16 v[220:223], v[152:155], v[164:167], v[220:223]
    v_mfma_f32_16x16x32_f16 v[220:223], v[156:159], v[160:163], v[220:223]
    s_setprio 3
    s_waitcnt lgkmcnt(0)
    v_cmp_gt_u32 vcc, 6, v19
    s_cbranch_vccnz L_cs43
L_cr44:
    s_cmp_lg_u32 s97, 0
    s_cbranch_scc1 L_cb47
    ds_write_b128 v51, v[208:211] offset:0
    ds_write_b128 v51, v[212:215] offset:1024
    ds_write_b128 v51, v[216:219] offset:2048
    ds_write_b128 v51, v[220:223] offset:3072
    v_mov_b32 v19, 7
    s_mov_b64 exec, 1
    ds_write_b32 v16, v19
    s_mov_b64 exec, -1
    s_mov_b32 s15, 0
L_s49:
    ds_read_b32 v19, v20 offset:0
    s_waitcnt lgkmcnt(0)
    v_cmp_gt_u32 vcc, 7, v19
    s_cbranch_vccz L_sd50
    s_add_u32 s15, s15, 1
    s_cmp_lt_u32 s15, 0x40000
    s_cbranch_scc1 L_s49
L_sd50:
    ds_read_b128 v[64:67], v7 offset:0
    ds_read_b128 v[68:71], v7 offset:1024
    ds_read_b128 v[72:75], v7 offset:2048
    ds_read_b128 v[76:79], v7 offset:3072
    s_waitcnt lgkmcnt(3)
    v_add_f32 v192, v192, v64
    v_add_f32 v193, v193, v65
    v_mul_f32 v192, v21, v192
    v_mul_f32 v193, v21, v193
    v_cvt_pk_bf16_f32 v193, v192, v193
    v_lshlrev_b32 v192, 16, v193
    v_and_b32 v193, 0xffff0000, v193
    v_add_f32 v192, v192, v224
    v_add_f32 v193, v193, v225
    v_cvt_pk_bf16_f32 v80, v192, v193
    v_add_f32 v194, v194, v66
    v_add_f32 v195, v195, v67
    v_mul_f32 v194, v21, v194
    v_mul_f32 v195, v21, v195
    v_cvt_pk_bf16_f32 v195, v194, v195
    v_lshlrev_b32 v194, 16, v195
    v_and_b32 v195, 0xffff0000, v195
    v_add_f32 v194, v194, v226
    v_add_f32 v195, v195, v227
    v_cvt_pk_bf16_f32 v81, v194, v195
    buffer_store_dwordx2 v[80:81], v52, s[68:71], s92 offen offset:0 sc1
    s_waitcnt lgkmcnt(2)
    v_add_f32 v196, v196, v68
    v_add_f32 v197, v197, v69
    v_mul_f32 v196, v21, v196
    v_mul_f32 v197, v21, v197
    v_cvt_pk_bf16_f32 v197, v196, v197
    v_lshlrev_b32 v196, 16, v197
    v_and_b32 v197, 0xffff0000, v197
    v_add_f32 v196, v196, v228
    v_add_f32 v197, v197, v229
    v_cvt_pk_bf16_f32 v82, v196, v197
    v_add_f32 v198, v198, v70
    v_add_f32 v199, v199, v71
    v_mul_f32 v198, v21, v198
    v_mul_f32 v199, v21, v199
    v_cvt_pk_bf16_f32 v199, v198, v199
    v_lshlrev_b32 v198, 16, v199
    v_and_b32 v199, 0xffff0000, v199
    v_add_f32 v198, v198, v230
    v_add_f32 v199, v199, v231
    v_cvt_pk_bf16_f32 v83, v198, v199
    buffer_store_dwordx2 v[82:83], v52, s[68:71], s92 offen offset:512 sc1
    s_waitcnt lgkmcnt(1)
    v_add_f32 v200, v200, v72
    v_add_f32 v201, v201, v73
    v_mul_f32 v200, v21, v200
    v_mul_f32 v201, v21, v201
    v_cvt_pk_bf16_f32 v201, v200, v201
    v_lshlrev_b32 v200, 16, v201
    v_and_b32 v201, 0xffff0000, v201
    v_add_f32 v200, v200, v232
    v_add_f32 v201, v201, v233
    v_cvt_pk_bf16_f32 v84, v200, v201
    v_add_f32 v202, v202, v74
    v_add_f32 v203, v203, v75
    v_mul_f32 v202, v21, v202
    v_mul_f32 v203, v21, v203
    v_cvt_pk_bf16_f32 v203, v202, v203
    v_lshlrev_b32 v202, 16, v203
    v_and_b32 v203, 0xffff0000, v203
    v_add_f32 v202, v202, v234
    v_add_f32 v203, v203, v235
    v_cvt_pk_bf16_f32 v85, v202, v203
    buffer_store_dwordx2 v[84:85], v52, s[68:71], s92 offen offset:1024 sc1
    s_waitcnt lgkmcnt(0)
    v_add_f32 v204, v204, v76
    v_add_f32 v205, v205, v77
    v_mul_f32 v204, v21, v204
    v_mul_f32 v205, v21, v205
    v_cvt_pk_bf16_f32 v205, v204, v205
    v_lshlrev_b32 v204, 16, v205
    v_and_b32 v205, 0xffff0000, v205
    v_add_f32 v204, v204, v236
    v_add_f32 v205, v205, v237
    v_cvt_pk_bf16_f32 v86, v204, v205
    v_add_f32 v206, v206, v78
    v_add_f32 v207, v207, v79
    v_mul_f32 v206, v21, v206
    v_mul_f32 v207, v21, v207
    v_cvt_pk_bf16_f32 v207, v206, v207
    v_lshlrev_b32 v206, 16, v207
    v_and_b32 v207, 0xffff0000, v207
    v_add_f32 v206, v206, v238
    v_add_f32 v207, v207, v239
    v_cvt_pk_bf16_f32 v87, v206, v207
    buffer_store_dwordx2 v[86:87], v52, s[68:71], s92 offen offset:1536 sc1
    s_branch L_cj48
L_cb47:
    s_nop 7
    ds_write_b128 v51, v[192:195] offset:0
    ds_write_b128 v51, v[196:199] offset:1024
    ds_write_b128 v51, v[200:203] offset:2048
    ds_write_b128 v51, v[204:207] offset:3072
    v_mov_b32 v19, 7
    s_mov_b64 exec, 1
    ds_write_b32 v16, v19
    s_mov_b64 exec, -1
    s_mov_b32 s15, 0
L_s51:
    ds_read_b32 v19, v20 offset:0
    s_waitcnt lgkmcnt(0)
    v_cmp_gt_u32 vcc, 7, v19
    s_cbranch_vccz L_sd52
    s_add_u32 s15, s15, 1
    s_cmp_lt_u32 s15, 0x40000
    s_cbranch_scc1 L_s51
L_sd52:
    ds_read_b128 v[64:67], v7 offset:0
    ds_read_b128 v[68:71], v7 offset:1024
    ds_read_b128 v[72:75], v7 offset:2048
    ds_read_b128 v[76:79], v7 offset:3072
    s_waitcnt lgkmcnt(3)
    v_add_f32 v208, v208, v64
    v_add_f32 v209, v209, v65
    v_mul_f32 v208, v21, v208
    v_mul_f32 v209, v21, v209
    v_cvt_pk_bf16_f32 v209, v208, v209
    v_lshlrev_b32 v208, 16, v209
    v_and_b32 v209, 0xffff0000, v209
    v_add_f32 v208, v208, v224
    v_add_f32 v209, v209, v225
    v_cvt_pk_bf16_f32 v80, v208, v209
    v_add_f32 v210, v210, v66
    v_add_f32 v211, v211, v67
    v_mul_f32 v210, v21, v210
    v_mul_f32 v211, v21, v211
    v_cvt_pk_bf16_f32 v211, v210, v211
    v_lshlrev_b32 v210, 16, v211
    v_and_b32 v211, 0xffff0000, v211
    v_add_f32 v210, v210, v226
    v_add_f32 v211, v211, v227
    v_cvt_pk_bf16_f32 v81, v210, v211
    buffer_store_dwordx2 v[80:81], v52, s[68:71], s92 offen offset:0 sc1
    s_waitcnt lgkmcnt(2)
    v_add_f32 v212, v212, v68
    v_add_f32 v213, v213, v69
    v_mul_f32 v212, v21, v212
    v_mul_f32 v213, v21, v213
    v_cvt_pk_bf16_f32 v213, v212, v213
    v_lshlrev_b32 v212, 16, v213
    v_and_b32 v213, 0xffff0000, v213
    v_add_f32 v212, v212, v228
    v_add_f32 v213, v213, v229
    v_cvt_pk_bf16_f32 v82, v212, v213
    v_add_f32 v214, v214, v70
    v_add_f32 v215, v215, v71
    v_mul_f32 v214, v21, v214
    v_mul_f32 v215, v21, v215
    v_cvt_pk_bf16_f32 v215, v214, v215
    v_lshlrev_b32 v214, 16, v215
    v_and_b32 v215, 0xffff0000, v215
    v_add_f32 v214, v214, v230
    v_add_f32 v215, v215, v231
    v_cvt_pk_bf16_f32 v83, v214, v215
    buffer_store_dwordx2 v[82:83], v52, s[68:71], s92 offen offset:512 sc1
    s_waitcnt lgkmcnt(1)
    v_add_f32 v216, v216, v72
    v_add_f32 v217, v217, v73
    v_mul_f32 v216, v21, v216
    v_mul_f32 v217, v21, v217
    v_cvt_pk_bf16_f32 v217, v216, v217
    v_lshlrev_b32 v216, 16, v217
    v_and_b32 v217, 0xffff0000, v217
    v_add_f32 v216, v216, v232
    v_add_f32 v217, v217, v233
    v_cvt_pk_bf16_f32 v84, v216, v217
    v_add_f32 v218, v218, v74
    v_add_f32 v219, v219, v75
    v_mul_f32 v218, v21, v218
    v_mul_f32 v219, v21, v219
    v_cvt_pk_bf16_f32 v219, v218, v219
    v_lshlrev_b32 v218, 16, v219
    v_and_b32 v219, 0xffff0000, v219
    v_add_f32 v218, v218, v234
    v_add_f32 v219, v219, v235
    v_cvt_pk_bf16_f32 v85, v218, v219
    buffer_store_dwordx2 v[84:85], v52, s[68:71], s92 offen offset:1024 sc1
    s_waitcnt lgkmcnt(0)
    v_add_f32 v220, v220, v76
    v_add_f32 v221, v221, v77
    v_mul_f32 v220, v21, v220
    v_mul_f32 v221, v21, v221
    v_cvt_pk_bf16_f32 v221, v220, v221
    v_lshlrev_b32 v220, 16, v221
    v_and_b32 v221, 0xffff0000, v221
    v_add_f32 v220, v220, v236
    v_add_f32 v221, v221, v237
    v_cvt_pk_bf16_f32 v86, v220, v221
    v_add_f32 v222, v222, v78
    v_add_f32 v223, v223, v79
    v_mul_f32 v222, v21, v222
    v_mul_f32 v223, v21, v223
    v_cvt_pk_bf16_f32 v223, v222, v223
    v_lshlrev_b32 v222, 16, v223
    v_and_b32 v223, 0xffff0000, v223
    v_add_f32 v222, v222, v238
    v_add_f32 v223, v223, v239
    v_cvt_pk_bf16_f32 v87, v222, v223
    buffer_store_dwordx2 v[86:87], v52, s[68:71], s92 offen offset:1536 sc1
L_cj48:
    s_setprio 0
    v_subrev_u32 v72, 16, v16
    s_mov_b32 s15, 0
L_s53:
    ds_read_b32 v19, v72 offset:0
    s_waitcnt lgkmcnt(0)
    v_cmp_gt_u32 vcc, 4, v19
    s_cbranch_vccz L_sd54
    s_sleep 2
    s_add_u32 s15, s15, 1
    s_cmp_lt_u32 s15, 0x40000
    s_cbranch_scc1 L_s53
L_sd54:
    s_mov_b32 s15, 0
L_yp55:
    buffer_load_dwordx4 v[64:67], v53, s[68:71], s86 offen sc1
    buffer_load_dwordx4 v[68:71], v53, s[68:71], s87 offen sc1
    s_waitcnt vmcnt(0)
    v_max3_u32 v72, v64, v65, v66
    v_max3_u32 v72, v72, v67, v68
    v_max3_u32 v72, v72, v69, v70
    v_max_u32 v72, v72, v71
    v_cmp_eq_u32 vcc, -1, v72
    s_cbranch_vccz L_yd56
    s_sleep 6
    s_add_u32 s15, s15, 1
    s_cmp_lt_u32 s15, 0x4000
    s_cbranch_scc1 L_yp55
L_yd56:
    ds_write_b128 v54, v[64:67]
    ds_write_b128 v54, v[68:71] offset:1024
    s_waitcnt lgkmcnt(0)
    s_barrier
L_end:
    s_endpgm
L_spare:
    s_waitcnt lgkmcnt(0)
    s_barrier
    s_barrier
    v_mov_b32 v19, 163832
    ds_read_b32 v29, v19
    ds_read_b32 v31, v19
    s_waitcnt lgkmcnt(0)
    buffer_store_dwordx4 v[4:7], v1, s[68:71], s92 offen sc1
    buffer_store_dwordx4 v[12:15], v1, s[68:71], s92 offen offset:1024 sc1
    v_readfirstlane_b32 s89, v29
    s_mov_b64 exec, 3
    buffer_store_dwordx4 v[28:31], v1, s[68:71], s94 offen sc1
    s_mov_b64 exec, -1
    v_mov_b32 v4, -1
    v_mov_b32 v5, -1
    v_mov_b32 v6, -1
    v_mov_b32 v7, -1
    buffer_store_dwordx4 v[4:7], v1, s[68:71], s95 offen sc1
    buffer_store_dwordx4 v[4:7], v1, s[68:71], s95 offen offset:1024 sc1
    s_waitcnt vmcnt(0)
    s_mov_b64 exec, 1
    buffer_store_dword v29, v18, s[68:71], s76 offen sc1
    s_mov_b64 exec, -1
    v_lshlrev_b32 v12, 1, v24
    v_xor_b32 v12, v12, v23
    v_lshlrev_b32 v12, 4, v12
    v_lshl_add_u32 v12, v22, 10, v12
    v_add_u32 v13, 7168, v12
    v_add_u32 v14, 14336, v12
    v_add_u32 v15, 21504, v12
    s_lshl_b32 s13, s96, 8
    s_add_u32 s13, s13, 118784
    v_lshl_add_u32 v22, v27, 2, s13
    s_and_b32 s13, s5, 3
    s_lshl_b32 s13, s13, 2
    s_add_u32 s13, s13, s12
    s_add_u32 s13, s13, s4
    s_add_u32 s13, s13, s4
    s_and_b32 s13, s13, 15
    s_mul_i32 s13, s13, 114688
    s_add_u32 s13, s13, 98304
    s_barrier
    buffer_load_dwordx4 v[32:35], v1, s[56:59], s13 offen offset:0
    buffer_load_dwordx4 v[32:35], v1, s[56:59], s13 offen offset:1024
    buffer_load_dwordx4 v[32:35], v1, s[56:59], s13 offen offset:2048
    buffer_load_dwordx4 v[32:35], v1, s[56:59], s13 offen offset:3072
    s_add_u32 s13, s13, 4096
    s_barrier
    s_barrier
    buffer_load_dwordx4 v[32:35], v1, s[56:59], s13 offen offset:0
    buffer_load_dwordx4 v[32:35], v1, s[56:59], s13 offen offset:1024
    buffer_load_dwordx4 v[32:35], v1, s[56:59], s13 offen offset:2048
    buffer_load_dwordx4 v[32:35], v1, s[56:59], s13 offen offset:3072
    s_add_u32 s13, s13, 4096
    s_barrier
    s_barrier
    buffer_load_dwordx4 v[32:35], v1, s[56:59], s13 offen offset:0
    buffer_load_dwordx4 v[32:35], v1, s[56:59], s13 offen offset:1024
    buffer_load_dwordx4 v[32:35], v1, s[56:59], s13 offen offset:2048
    buffer_load_dwordx4 v[32:35], v1, s[56:59], s13 offen offset:3072
    s_add_u32 s13, s13, 4096
    s_barrier
    s_barrier
    buffer_load_dwordx4 v[32:35], v1, s[56:59], s13 offen offset:0
    buffer_load_dwordx4 v[32:35], v1, s[56:59], s13 offen offset:1024
    buffer_load_dwordx4 v[32:35], v1, s[56:59], s13 offen offset:2048
    buffer_load_dwordx4 v[32:35], v1, s[56:59], s13 offen offset:3072
    s_add_u32 s13, s13, 4096
    s_barrier
    s_barrier
    s_barrier
    s_barrier
    s_barrier
    v_mov_b32 v19, 3
    s_mov_b64 exec, 1
    ds_write_b32 v16, v19
    s_mov_b64 exec, -1
    s_waitcnt vmcnt(0)
    s_branch L_join
L_cs1:
    s_mov_b32 s15, 0
L_s3:
    ds_read_b32 v19, v17 offset:16
    s_waitcnt lgkmcnt(0)
    v_cmp_gt_u32 vcc, 1, v19
    s_cbranch_vccz L_sd4
    s_add_u32 s15, s15, 1
    s_cmp_lt_u32 s15, 0x40000
    s_cbranch_scc1 L_s3
L_sd4:
    s_branch L_cr2
L_cs5:
    s_mov_b32 s15, 0
L_s7:
    ds_read_b32 v19, v17 offset:0
    s_waitcnt lgkmcnt(0)
    v_cmp_gt_u32 vcc, 2, v19
    s_cbranch_vccz L_sd8
    s_add_u32 s15, s15, 1
    s_cmp_lt_u32 s15, 0x40000
    s_cbranch_scc1 L_s7
L_sd8:
    s_branch L_cr6
L_cs9:
    s_mov_b32 s15, 0
L_s11:
    ds_read_b32 v10, v17 offset:16
    s_waitcnt lgkmcnt(0)
    v_cmp_gt_u32 vcc, 4, v10
    s_cbranch_vccz L_sd12
    s_add_u32 s15, s15, 1
    s_cmp_lt_u32 s15, 0x40000
    s_cbranch_scc1 L_s11
L_sd12:
    s_branch L_cr10
L_hs13:
    s_mov_b32 s14, 0
L_hp15:
    buffer_load_dword v11, v10, s[68:71], s94 offen offset:0 sc1
    s_waitcnt vmcnt(0)
    v_cmp_ne_u32 vcc, s89, v11
    s_cbranch_vccz L_hr14
    s_sleep 1
    s_add_u32 s14, s14, 1
    s_cmp_lt_u32 s14, 0x8000
    s_cbranch_scc1 L_hp15
    s_branch L_hr14
L_hs16:
    s_mov_b32 s14, 0
L_hp18:
    buffer_load_dword v11, v10, s[68:71], s94 offen offset:4 sc1
    s_waitcnt vmcnt(0)
    v_cmp_ne_u32 vcc, s89, v11
    s_cbranch_vccz L_hr17
    s_sleep 1
    s_add_u32 s14, s14, 1
    s_cmp_lt_u32 s14, 0x8000
    s_cbranch_scc1 L_hp18
    s_branch L_hr17
L_rs19:
    s_mov_b32 s14, 0
L_rp21:
    buffer_load_dwordx2 v[28:29], v27, s[68:71], s77 offen sc1
    s_waitcnt vmcnt(0)
    v_cmp_ne_u32 vcc, s89, v29
    s_cbranch_vccz L_rr20
    s_sleep 2
    s_add_u32 s14, s14, 1
    s_cmp_lt_u32 s14, 0x4000
    s_cbranch_scc1 L_rp21
    s_branch L_rr20
L_ns24:
    s_mov_b32 s14, 0
L_np26:
    buffer_load_dword v84, v18, s[64:67], 0 offen sc1
    s_waitcnt vmcnt(0)
    v_cmp_eq_u32 vcc, 0, v84
    s_cbranch_vccz L_pl25
    s_sleep 4
    s_add_u32 s14, s14, 1
    s_cmp_lt_u32 s14, 0x8000
    s_cbranch_scc1 L_np26
    s_branch L_pl25
L_cq28:
    s_add_u32 s14, s14, 1
    s_cmp_ge_u32 s14, 0x4000
    s_cbranch_scc1 L_pl29
    s_sleep 4
    buffer_load_dwordx4 v[92:95], v79, s[72:75], s94 offen sc1
    buffer_load_dwordx4 v[96:99], v79, s[72:75], s94 offen offset:16 sc1
    buffer_load_dwordx2 v[100:101], v86, s[72:75], s15 offen sc1
    s_waitcnt vmcnt(0)
    s_branch L_cc27
L_ps30:
    s_mov_b32 s14, 0
L_pp32:
    s_sleep 4
    buffer_load_dwordx4 v[104:107], v79, s[68:71], s95 offen sc1
    s_waitcnt vmcnt(0)
    v_min3_u32 v102, v104, v105, v106
    v_max3_u32 v103, v104, v105, v106
    v_min_u32 v102, v102, v107
    v_max_u32 v103, v103, v107
    v_xor_b32 v102, s89, v102
    v_xor_b32 v103, s89, v103
    v_or_b32 v102, v102, v103
    v_cmp_ne_u32 vcc, 0, v102
    s_cbranch_vccz L_pl31
    s_add_u32 s14, s14, 1
    s_cmp_lt_u32 s14, 0x8000
    s_cbranch_scc1 L_pp32
    s_branch L_pl31
L_cs43:
    s_mov_b32 s15, 0
L_s45:
    ds_read_b32 v19, v20 offset:0
    s_waitcnt lgkmcnt(0)
    v_cmp_gt_u32 vcc, 6, v19
    s_cbranch_vccz L_sd46
    s_add_u32 s15, s15, 1
    s_cmp_lt_u32 s15, 0x40000
    s_cbranch_scc1 L_s45
L_sd46:
    s_branch L_cr44
L_codeend:
.section .rodata,"a"
.p2align 6
.amdhsa_kernel parallel_sum__ssm_conv_s4d__glu_gated_bilinear__prompt_kernel
  .amdhsa_next_free_vgpr 256
  .amdhsa_next_free_sgpr 102
  .amdhsa_accum_offset 256
  .amdhsa_group_segment_fixed_size 0
  .amdhsa_kernarg_size 112
  .amdhsa_user_sgpr_count 2
  .amdhsa_user_sgpr_kernarg_segment_ptr 1
  .amdhsa_system_sgpr_workgroup_id_x 1
  .amdhsa_float_denorm_mode_32 3
.end_amdhsa_kernel
```
